```python
import torch

def _softmax(x, axis=-1):
    return torch.softmax(x, dim=axis)

def _gelu(x):
    return torch.nn.functional.gelu(x, approximate='tanh')

def _silu(x):
    return torch.nn.functional.silu(x)

def _sigmoid(x):
    return torch.sigmoid(x)

def _layernorm(x, axis=-1, eps=1e-05):
    m = x.mean(dim=axis, keepdim=True)
    v = x.var(dim=axis, keepdim=True, unbiased=False)
    return (x - m) / torch.sqrt(v + eps)

def _scatter_add(tgt, idx, src, axis=0):
    return tgt.clone().index_add_(axis, idx, src)

def _segment_sum(src, seg, n):
    out = torch.zeros((n,) + src.shape[1:], dtype=src.dtype)
    return out.index_add_(0, seg, src)

def _pad(x, pw):
    flat = tuple((v for pair in reversed(pw) for v in pair))
    return torch.nn.functional.pad(x, flat)
kernel_name = 'adaLN_cond__grouped_kv_mqa__dense_activation_relu__prompt'

def setup_inputs():

    _w = lambda a: (lambda t: t.to(torch.bfloat16) if t.is_floating_point() else t)(torch.as_tensor(a))

    def _A_setup():
        B, S, D, H = (1, 2048, 576, 32)
        Dh = D // H
        return {'x': _w((lambda *s: torch.randn(*s, dtype=torch.bfloat16) * 0.05)(B, S, D)), 'wq': _w((lambda *s: torch.randn(*s, dtype=torch.bfloat16) * 0.05)(D, H * Dh)), 'wk': _w((lambda *s: torch.randn(*s, dtype=torch.bfloat16) * 0.05)(D, Dh)), 'wv': _w((lambda *s: torch.randn(*s, dtype=torch.bfloat16) * 0.05)(D, Dh)), 'wo': _w((lambda *s: torch.randn(*s, dtype=torch.bfloat16) * 0.05)(H * Dh, D))}
    _A_in = _A_setup()

    def _B_setup():
        B, S, D, Dff = (1, 2048, 576, 4608)
        return {'x': _w((lambda *s: torch.randn(*s, dtype=torch.bfloat16) * 0.05)(B, S, D)), 'w1': _w((lambda *s: torch.randn(*s, dtype=torch.bfloat16) * 0.05)(D, Dff)), 'w2': _w((lambda *s: torch.randn(*s, dtype=torch.bfloat16) * 0.05)(Dff, D))}
    _B_in = _B_setup()
    return {'A_x': _A_in['x'], 'A_wq': _A_in['wq'], 'A_wk': _A_in['wk'], 'A_wv': _A_in['wv'], 'A_wo': _A_in['wo'], 'B_x': _B_in['x'], 'B_w1': _B_in['w1'], 'B_w2': _B_in['w2'], 'c': _w((lambda *s: torch.randn(*s, dtype=torch.bfloat16) * 0.1)(1, 576) * 8.0), 'w_mod': _w((lambda *s: torch.randn(*s, dtype=torch.bfloat16) * 0.1)(576, 6 * 576) * 576 ** (-0.5) * 8.0)}

def reference(A_x, A_wq, A_wk, A_wv, A_wo, B_x, B_w1, B_w2, c, w_mod):

    def _A_ref(x, wq, wk, wv, wo):
        B, S, D = x.shape
        H = 32
        Dh = D // H
        q = (lambda x, *d: x.permute(*d))((x @ wq).reshape(B, S, H, Dh), 0, 2, 1, 3)
        k = x @ wk
        v = x @ wv
        scores = torch.einsum('bhqd,bkd->bhqk', q, k) * Dh ** (-0.5)
        p = _softmax(scores, axis=-1)
        o = torch.einsum('bhqk,bkd->bhqd', p, v)
        return (lambda x, *d: x.permute(*d))(o, 0, 2, 1, 3).reshape(B, S, H * Dh) @ wo

    def _B_ref(x, w1, w2):
        h = torch.einsum('bsd,df->bsf', x, w1)
        zero = torch.zeros_like(h)
        h = torch.maximum(h, zero)
        return torch.einsum('bsf,fd->bsd', h, w2)
    x = A_x
    mod = (_silu(c) @ w_mod).reshape(c.shape[0], 6, 1, -1)
    sa, ca, ga, sb, cb, gb = (mod[:, 0].clone(), mod[:, 1].clone(), mod[:, 2].clone(), mod[:, 3].clone(), mod[:, 4].clone(), mod[:, 5].clone())
    h = _layernorm(x, axis=-1) * (1 + ca) + sa
    x = x + ga * _A_ref(h, A_wq, A_wk, A_wv, A_wo)
    h = _layernorm(x, axis=-1) * (1 + cb) + sb
    x = x + gb * _B_ref(h, B_w1, B_w2)
    return x
```

```asm
; @launch kernel=adaLN_cond__grouped_kv_mqa__dense_activation_relu__prompt_kernel grid=(256,1,1) block=(1024,1,1) lds=163840
.amdgcn_target "amdgcn-amd-amdhsa--gfx950"
.text
.globl adaLN_cond__grouped_kv_mqa__dense_activation_relu__prompt_kernel
.p2align 8
.type adaLN_cond__grouped_kv_mqa__dense_activation_relu__prompt_kernel,@function
adaLN_cond__grouped_kv_mqa__dense_activation_relu__prompt_kernel:
    s_cmp_ge_u32 s2, 256
    s_cbranch_scc1 L_kb_end
    s_load_dwordx2 s[4:5], s[0:1], 96
    s_load_dwordx8 s[24:31], s[0:1], 0
    s_load_dwordx2 s[32:33], s[0:1], 32
    s_load_dwordx4 s[36:39], s[0:1], 64
    s_load_dwordx2 s[40:41], s[0:1], 88
    v_lshrrev_b32 v1, 6, v0
    v_and_b32 v2, 63, v0
    v_readfirstlane_b32 s6, v1
    v_and_b32 v3, 15, v2
    v_lshrrev_b32 v4, 4, v2
    v_lshlrev_b32 v1, 4, v2
    s_mov_b32 s63, s2
    s_and_b32 s9, s63, 7
    s_lshl_b32 s9, s9, 5
    s_lshr_b32 s2, s63, 3
    s_add_u32 s2, s2, s9
    s_and_b32 s21, s2, 3
    s_lshr_b32 s20, s2, 2
    s_waitcnt lgkmcnt(0)
    s_load_dword s34, s[4:5], 262144
    s_mov_b32 s12, s4
    s_mov_b32 s13, s5
    s_mov_b32 s14, 67108864
    s_mov_b32 s15, 0x20000
    s_cmp_ge_u32 s6, 13
    s_cbranch_scc1 L_ka_misc
    s_cmp_ge_u32 s6, 4
    s_cbranch_scc1 L_ka_prep
    s_lshr_b32 s9, s63, 3
    s_and_b32 s10, s63, 7
    s_lshr_b32 s42, s9, 2
    s_lshl_b32 s42, s42, 5
    s_lshl_b32 s10, s10, 2
    s_add_u32 s42, s42, s10
    s_and_b32 s9, s9, 3
    s_add_u32 s42, s42, s9
    s_cmp_ge_u32 s42, 216
    s_cbranch_scc1 L_ka_b1
    s_lshl_b32 s43, s42, 5
    v_lshrrev_b32 v5, 1, v0
    v_and_b32 v6, 1, v0
    v_lshlrev_b32 v6, 4, v6
    v_mul_u32_u24 v80, 6912, v5
    v_add_u32 v80, v80, v6
    v_lshlrev_b32 v7, 1, v5
    v_add_u32 v81, 884736, v80
    v_add_u32 v82, 1769472, v80
    v_add_u32 v83, 2654208, v80
    v_add_u32 v84, 3538944, v80
    s_mov_b32 s16, s36
    s_mov_b32 s17, s37
    s_mov_b32 s18, 1152
    s_mov_b32 s19, 0x20000
    s_mov_b32 s44, s38
    s_mov_b32 s45, s39
    s_mov_b32 s46, 3981312
    s_mov_b32 s47, 0x20000
    buffer_load_dwordx4 v[16:19], v80, s[44:47], s43 offen
    buffer_load_dwordx4 v[20:23], v81, s[44:47], s43 offen
    buffer_load_dwordx4 v[24:27], v82, s[44:47], s43 offen
    buffer_load_dwordx4 v[28:31], v83, s[44:47], s43 offen
    buffer_load_dwordx4 v[32:35], v84, s[44:47], s43 offen
    s_cmp_ge_u32 s42, 72
    s_cbranch_scc1 L_ka_nmg
    s_cmp_lg_u32 s6, 0
    s_cbranch_scc1 L_ka_nmg
    s_lshl_b32 s11, s42, 7
    s_add_u32 s11, s11, 360448
    v_mov_b32 v60, 0
    s_mov_b64 exec, 1
    buffer_load_dword v61, v60, s[12:15], s11 offen sc1
    s_mov_b64 exec, -1
L_ka_nmg:
    buffer_load_ushort v10, v7, s[16:19], 0 offen offset:0
    buffer_load_ushort v11, v7, s[16:19], 0 offen offset:256
    buffer_load_ushort v12, v7, s[16:19], 0 offen offset:512
    buffer_load_ushort v13, v7, s[16:19], 0 offen offset:768
    buffer_load_ushort v14, v7, s[16:19], 0 offen offset:1024
    v_mov_b32 v40, 0
    v_mov_b32 v41, 0
    v_mov_b32 v42, 0
    v_mov_b32 v43, 0
    v_mov_b32 v44, 0
    v_mov_b32 v45, 0
    v_mov_b32 v46, 0
    v_mov_b32 v47, 0
    s_mov_b32 s9, 0xbfb8aa3b
    s_waitcnt vmcnt(0)
    v_lshlrev_b32 v10, 16, v10
    v_lshlrev_b32 v11, 16, v11
    v_lshlrev_b32 v12, 16, v12
    v_lshlrev_b32 v13, 16, v13
    v_lshlrev_b32 v14, 16, v14
    v_mul_f32 v50, s9, v10
    v_mul_f32 v51, s9, v11
    v_mul_f32 v52, s9, v12
    v_mul_f32 v53, s9, v13
    v_mul_f32 v54, s9, v14
    v_exp_f32 v50, v50
    v_exp_f32 v51, v51
    v_exp_f32 v52, v52
    v_exp_f32 v53, v53
    v_exp_f32 v54, v54
    s_nop 0
    v_add_f32 v50, 1.0, v50
    v_add_f32 v51, 1.0, v51
    v_add_f32 v52, 1.0, v52
    v_add_f32 v53, 1.0, v53
    v_add_f32 v54, 1.0, v54
    v_rcp_f32 v50, v50
    v_rcp_f32 v51, v51
    v_rcp_f32 v52, v52
    v_rcp_f32 v53, v53
    v_rcp_f32 v54, v54
    s_nop 0
    v_mul_f32 v50, v50, v10
    v_mul_f32 v51, v51, v11
    v_mul_f32 v52, v52, v12
    v_mul_f32 v53, v53, v13
    v_mul_f32 v54, v54, v14
    v_cvt_pk_bf16_f32 v50, v50, v50
    v_cvt_pk_bf16_f32 v51, v51, v51
    v_cvt_pk_bf16_f32 v52, v52, v52
    v_cvt_pk_bf16_f32 v53, v53, v53
    v_cvt_pk_bf16_f32 v54, v54, v54
    v_lshlrev_b32 v50, 16, v50
    v_lshlrev_b32 v51, 16, v51
    v_lshlrev_b32 v52, 16, v52
    v_lshlrev_b32 v53, 16, v53
    v_lshlrev_b32 v54, 16, v54
    v_lshlrev_b32 v56, 16, v16
    v_and_b32 v57, 0xffff0000, v16
    v_fmac_f32 v40, v50, v56
    v_fmac_f32 v41, v50, v57
    v_lshlrev_b32 v56, 16, v17
    v_and_b32 v57, 0xffff0000, v17
    v_fmac_f32 v42, v50, v56
    v_fmac_f32 v43, v50, v57
    v_lshlrev_b32 v56, 16, v18
    v_and_b32 v57, 0xffff0000, v18
    v_fmac_f32 v44, v50, v56
    v_fmac_f32 v45, v50, v57
    v_lshlrev_b32 v56, 16, v19
    v_and_b32 v57, 0xffff0000, v19
    v_fmac_f32 v46, v50, v56
    v_fmac_f32 v47, v50, v57
    v_lshlrev_b32 v56, 16, v20
    v_and_b32 v57, 0xffff0000, v20
    v_fmac_f32 v40, v51, v56
    v_fmac_f32 v41, v51, v57
    v_lshlrev_b32 v56, 16, v21
    v_and_b32 v57, 0xffff0000, v21
    v_fmac_f32 v42, v51, v56
    v_fmac_f32 v43, v51, v57
    v_lshlrev_b32 v56, 16, v22
    v_and_b32 v57, 0xffff0000, v22
    v_fmac_f32 v44, v51, v56
    v_fmac_f32 v45, v51, v57
    v_lshlrev_b32 v56, 16, v23
    v_and_b32 v57, 0xffff0000, v23
    v_fmac_f32 v46, v51, v56
    v_fmac_f32 v47, v51, v57
    v_lshlrev_b32 v56, 16, v24
    v_and_b32 v57, 0xffff0000, v24
    v_fmac_f32 v40, v52, v56
    v_fmac_f32 v41, v52, v57
    v_lshlrev_b32 v56, 16, v25
    v_and_b32 v57, 0xffff0000, v25
    v_fmac_f32 v42, v52, v56
    v_fmac_f32 v43, v52, v57
    v_lshlrev_b32 v56, 16, v26
    v_and_b32 v57, 0xffff0000, v26
    v_fmac_f32 v44, v52, v56
    v_fmac_f32 v45, v52, v57
    v_lshlrev_b32 v56, 16, v27
    v_and_b32 v57, 0xffff0000, v27
    v_fmac_f32 v46, v52, v56
    v_fmac_f32 v47, v52, v57
    v_lshlrev_b32 v56, 16, v28
    v_and_b32 v57, 0xffff0000, v28
    v_fmac_f32 v40, v53, v56
    v_fmac_f32 v41, v53, v57
    v_lshlrev_b32 v56, 16, v29
    v_and_b32 v57, 0xffff0000, v29
    v_fmac_f32 v42, v53, v56
    v_fmac_f32 v43, v53, v57
    v_lshlrev_b32 v56, 16, v30
    v_and_b32 v57, 0xffff0000, v30
    v_fmac_f32 v44, v53, v56
    v_fmac_f32 v45, v53, v57
    v_lshlrev_b32 v56, 16, v31
    v_and_b32 v57, 0xffff0000, v31
    v_fmac_f32 v46, v53, v56
    v_fmac_f32 v47, v53, v57
    v_lshlrev_b32 v56, 16, v32
    v_and_b32 v57, 0xffff0000, v32
    v_fmac_f32 v40, v54, v56
    v_fmac_f32 v41, v54, v57
    v_lshlrev_b32 v56, 16, v33
    v_and_b32 v57, 0xffff0000, v33
    v_fmac_f32 v42, v54, v56
    v_fmac_f32 v43, v54, v57
    v_lshlrev_b32 v56, 16, v34
    v_and_b32 v57, 0xffff0000, v34
    v_fmac_f32 v44, v54, v56
    v_fmac_f32 v45, v54, v57
    v_lshlrev_b32 v56, 16, v35
    v_and_b32 v57, 0xffff0000, v35
    v_fmac_f32 v46, v54, v56
    v_fmac_f32 v47, v54, v57
    s_nop 1
    v_add_f32_dpp v40, v40, v40 row_ror:2 row_mask:0xf bank_mask:0xf
    v_add_f32_dpp v41, v41, v41 row_ror:2 row_mask:0xf bank_mask:0xf
    v_add_f32_dpp v42, v42, v42 row_ror:2 row_mask:0xf bank_mask:0xf
    v_add_f32_dpp v43, v43, v43 row_ror:2 row_mask:0xf bank_mask:0xf
    v_add_f32_dpp v44, v44, v44 row_ror:2 row_mask:0xf bank_mask:0xf
    v_add_f32_dpp v45, v45, v45 row_ror:2 row_mask:0xf bank_mask:0xf
    v_add_f32_dpp v46, v46, v46 row_ror:2 row_mask:0xf bank_mask:0xf
    v_add_f32_dpp v47, v47, v47 row_ror:2 row_mask:0xf bank_mask:0xf
    v_add_f32_dpp v40, v40, v40 row_ror:4 row_mask:0xf bank_mask:0xf
    v_add_f32_dpp v41, v41, v41 row_ror:4 row_mask:0xf bank_mask:0xf
    v_add_f32_dpp v42, v42, v42 row_ror:4 row_mask:0xf bank_mask:0xf
    v_add_f32_dpp v43, v43, v43 row_ror:4 row_mask:0xf bank_mask:0xf
    v_add_f32_dpp v44, v44, v44 row_ror:4 row_mask:0xf bank_mask:0xf
    v_add_f32_dpp v45, v45, v45 row_ror:4 row_mask:0xf bank_mask:0xf
    v_add_f32_dpp v46, v46, v46 row_ror:4 row_mask:0xf bank_mask:0xf
    v_add_f32_dpp v47, v47, v47 row_ror:4 row_mask:0xf bank_mask:0xf
    v_add_f32_dpp v40, v40, v40 row_ror:8 row_mask:0xf bank_mask:0xf
    v_add_f32_dpp v41, v41, v41 row_ror:8 row_mask:0xf bank_mask:0xf
    v_add_f32_dpp v42, v42, v42 row_ror:8 row_mask:0xf bank_mask:0xf
    v_add_f32_dpp v43, v43, v43 row_ror:8 row_mask:0xf bank_mask:0xf
    v_add_f32_dpp v44, v44, v44 row_ror:8 row_mask:0xf bank_mask:0xf
    v_add_f32_dpp v45, v45, v45 row_ror:8 row_mask:0xf bank_mask:0xf
    v_add_f32_dpp v46, v46, v46 row_ror:8 row_mask:0xf bank_mask:0xf
    v_add_f32_dpp v47, v47, v47 row_ror:8 row_mask:0xf bank_mask:0xf
    v_lshrrev_b32 v5, 4, v0
    v_lshlrev_b32 v5, 6, v5
    v_lshl_add_u32 v5, v6, 1, v5
    v_add_u32 v5, 39168, v5
    v_cmp_gt_u32 vcc, 2, v3
    s_and_saveexec_b64 s[48:49], vcc
    ds_write_b128 v5, v[40:43]
    ds_write_b128 v5, v[44:47] offset:16
    s_mov_b64 exec, s[48:49]
    s_waitcnt lgkmcnt(0)
    s_mul_i32 s3, s34, 0x9E3779B1
    s_add_u32 s3, s3, 0x7F4A7C15
    s_lshl_b32 s9, s6, 2
    s_add_u32 s9, s9, 42496
    v_mov_b32 v5, s9
    v_mov_b32 v6, s3
    ds_write_b32 v5, v6
    s_cmp_lg_u32 s6, 0
    s_cbranch_scc1 L_ka_b1
    s_mov_b32 s11, 262144
L_ka_ms:
    ds_read_b128 v[16:19], v5
    s_waitcnt lgkmcnt(0)
    v_xor_b32 v17, s3, v17
    v_xor_b32 v18, s3, v18
    v_xor_b32 v19, s3, v19
    v_or3_b32 v17, v17, v18, v19
    v_cmp_ne_u32 vcc, 0, v17
    s_cbranch_vccz L_ka_msk
    s_sub_u32 s11, s11, 1
    s_cmp_lg_u32 s11, 0
    s_cbranch_scc1 L_ka_ms
L_ka_msk:
    v_lshlrev_b32 v5, 2, v3
    v_add_u32 v6, 39168, v5
    ds_read_b32 v16, v6 offset:0
    ds_read_b32 v17, v6 offset:64
    ds_read_b32 v18, v6 offset:128
    ds_read_b32 v19, v6 offset:192
    ds_read_b32 v20, v6 offset:256
    ds_read_b32 v21, v6 offset:320
    ds_read_b32 v22, v6 offset:384
    ds_read_b32 v23, v6 offset:448
    ds_read_b32 v24, v6 offset:512
    ds_read_b32 v25, v6 offset:576
    ds_read_b32 v26, v6 offset:640
    ds_read_b32 v27, v6 offset:704
    ds_read_b32 v28, v6 offset:768
    ds_read_b32 v29, v6 offset:832
    ds_read_b32 v30, v6 offset:896
    ds_read_b32 v31, v6 offset:960
    s_waitcnt lgkmcnt(0)
    v_add_f32 v16, v16, v24
    v_add_f32 v17, v17, v25
    v_add_f32 v18, v18, v26
    v_add_f32 v19, v19, v27
    v_add_f32 v20, v20, v28
    v_add_f32 v21, v21, v29
    v_add_f32 v22, v22, v30
    v_add_f32 v23, v23, v31
    v_add_f32 v16, v16, v20
    v_add_f32 v17, v17, v21
    v_add_f32 v18, v18, v22
    v_add_f32 v19, v19, v23
    v_add_f32 v16, v16, v18
    v_add_f32 v17, v17, v19
    v_add_f32 v16, v16, v17
    s_mul_i32 s9, s42, 1821
    s_lshr_b32 s9, s9, 16
    s_mul_i32 s10, s9, 36
    s_sub_u32 s10, s42, s10
    s_lshl_b32 s10, s10, 4
    v_cvt_pk_bf16_f32 v16, v16, v16
    v_lshlrev_b32 v16, 16, v16
    s_cmp_eq_u32 s9, 1
    s_cbranch_scc1 L_ka_plus1
    s_cmp_eq_u32 s9, 4
    s_cbranch_scc0 L_ka_noplus1
L_ka_plus1:
    v_add_f32 v16, 1.0, v16
    v_cvt_pk_bf16_f32 v16, v16, v16
    v_lshlrev_b32 v16, 16, v16
L_ka_noplus1:
    s_mov_b64 exec, 0xffff
    s_cmp_ge_u32 s9, 2
    s_cbranch_scc1 L_ka_plain
    v_mov_b32 v17, s3
    v_lshlrev_b32 v6, 3, v3
    s_lshl_b32 s11, s42, 7
    s_add_u32 s11, s11, 360448
    buffer_store_dwordx2 v[16:17], v6, s[12:15], s11 offen sc1
    s_branch L_ka_moddone
L_ka_plain:
    s_lshl_b32 s11, s42, 6
    buffer_store_dword v16, v5, s[12:15], s11 offen sc1
    s_cmp_eq_u32 s9, 4
    s_cselect_b32 s11, 0, 1152
    s_cbranch_scc1 L_ka_cbt
    s_cmp_eq_u32 s9, 3
    s_cbranch_scc0 L_ka_moddone
L_ka_cbt:
    s_lshl_b32 s10, s10, 1
    s_add_u32 s11, s11, s10
    s_add_u32 s11, s11, 16384
    v_lshlrev_b32 v6, 1, v3
    buffer_store_short_d16_hi v16, v6, s[12:15], s11 offen sc1
L_ka_moddone:
    s_mov_b64 exec, -1
    s_branch L_ka_b1
L_ka_prep:
    s_mov_b32 s16, s24
    s_mov_b32 s17, s25
    s_mov_b32 s18, 2359296
    s_mov_b32 s19, 0x20000
    s_sub_u32 s7, s6, 4
    v_mul_u32_u24 v6, 1152, v3
    v_lshl_add_u32 v6, v4, 4, v6
    s_mul_i32 s10, s20, 36864
    s_lshl_b32 s11, s7, 7
    s_add_u32 s10, s10, s11
    s_add_u32 s11, s10, 18432
    buffer_load_dwordx4 v[96:99], v6, s[16:19], s10 offen offset:0
    buffer_load_dwordx4 v[100:103], v6, s[16:19], s11 offen offset:0
    buffer_load_dwordx4 v[104:107], v6, s[16:19], s10 offen offset:64
    buffer_load_dwordx4 v[108:111], v6, s[16:19], s11 offen offset:64
    s_waitcnt vmcnt(0)
    v_lshlrev_b32 v40, 16, v96
    v_and_b32 v41, 0xffff0000, v96
    v_lshlrev_b32 v42, 16, v97
    v_and_b32 v43, 0xffff0000, v97
    v_lshlrev_b32 v44, 16, v98
    v_and_b32 v45, 0xffff0000, v98
    v_lshlrev_b32 v46, 16, v99
    v_and_b32 v47, 0xffff0000, v99
    v_lshlrev_b32 v48, 16, v104
    v_and_b32 v49, 0xffff0000, v104
    v_lshlrev_b32 v50, 16, v105
    v_and_b32 v51, 0xffff0000, v105
    v_lshlrev_b32 v52, 16, v106
    v_and_b32 v53, 0xffff0000, v106
    v_lshlrev_b32 v54, 16, v107
    v_and_b32 v55, 0xffff0000, v107
    v_lshlrev_b32 v56, 16, v100
    v_and_b32 v57, 0xffff0000, v100
    v_lshlrev_b32 v58, 16, v101
    v_and_b32 v59, 0xffff0000, v101
    v_lshlrev_b32 v60, 16, v102
    v_and_b32 v61, 0xffff0000, v102
    v_lshlrev_b32 v62, 16, v103
    v_and_b32 v63, 0xffff0000, v103
    v_lshlrev_b32 v64, 16, v108
    v_and_b32 v65, 0xffff0000, v108
    v_lshlrev_b32 v66, 16, v109
    v_and_b32 v67, 0xffff0000, v109
    v_lshlrev_b32 v68, 16, v110
    v_and_b32 v69, 0xffff0000, v110
    v_lshlrev_b32 v70, 16, v111
    v_and_b32 v71, 0xffff0000, v111
    v_pk_add_f32 v[80:81], v[40:41], v[42:43]
    v_pk_add_f32 v[80:81], v[80:81], v[44:45]
    v_pk_add_f32 v[80:81], v[80:81], v[46:47]
    v_pk_add_f32 v[80:81], v[80:81], v[48:49]
    v_pk_add_f32 v[80:81], v[80:81], v[50:51]
    v_pk_add_f32 v[80:81], v[80:81], v[52:53]
    v_pk_add_f32 v[80:81], v[80:81], v[54:55]
    v_pk_add_f32 v[82:83], v[56:57], v[58:59]
    v_pk_add_f32 v[82:83], v[82:83], v[60:61]
    v_pk_add_f32 v[82:83], v[82:83], v[62:63]
    v_pk_add_f32 v[82:83], v[82:83], v[64:65]
    v_pk_add_f32 v[82:83], v[82:83], v[66:67]
    v_pk_add_f32 v[82:83], v[82:83], v[68:69]
    v_pk_add_f32 v[82:83], v[82:83], v[70:71]
    v_add_f32 v84, v80, v81
    v_add_f32 v88, v82, v83
    v_mov_b32 v80, v84
    v_mov_b32 v81, v88
    s_nop 1
    v_permlane16_swap_b32 v84, v80
    v_permlane16_swap_b32 v88, v81
    s_nop 1
    v_add_f32 v84, v84, v80
    v_add_f32 v88, v88, v81
    v_mov_b32 v80, v84
    v_mov_b32 v81, v88
    s_nop 1
    v_permlane32_swap_b32 v84, v80
    v_permlane32_swap_b32 v88, v81
    s_nop 1
    v_add_f32 v84, v84, v80
    v_add_f32 v88, v88, v81
    v_mul_f32 v84, 0x3c800000, v84
    v_mul_f32 v88, 0x3c800000, v88
    v_mov_b32 v85, v84
    v_mov_b32 v89, v88
    v_pk_add_f32 v[80:81], v[40:41], v[84:85] neg_lo:[0,1] neg_hi:[0,1]
    v_pk_mul_f32 v[86:87], v[80:81], v[80:81]
    v_pk_add_f32 v[80:81], v[42:43], v[84:85] neg_lo:[0,1] neg_hi:[0,1]
    v_pk_fma_f32 v[86:87], v[80:81], v[80:81], v[86:87]
    v_pk_add_f32 v[80:81], v[44:45], v[84:85] neg_lo:[0,1] neg_hi:[0,1]
    v_pk_fma_f32 v[86:87], v[80:81], v[80:81], v[86:87]
    v_pk_add_f32 v[80:81], v[46:47], v[84:85] neg_lo:[0,1] neg_hi:[0,1]
    v_pk_fma_f32 v[86:87], v[80:81], v[80:81], v[86:87]
    v_pk_add_f32 v[80:81], v[48:49], v[84:85] neg_lo:[0,1] neg_hi:[0,1]
    v_pk_fma_f32 v[86:87], v[80:81], v[80:81], v[86:87]
    v_pk_add_f32 v[80:81], v[50:51], v[84:85] neg_lo:[0,1] neg_hi:[0,1]
    v_pk_fma_f32 v[86:87], v[80:81], v[80:81], v[86:87]
    v_pk_add_f32 v[80:81], v[52:53], v[84:85] neg_lo:[0,1] neg_hi:[0,1]
    v_pk_fma_f32 v[86:87], v[80:81], v[80:81], v[86:87]
    v_pk_add_f32 v[80:81], v[54:55], v[84:85] neg_lo:[0,1] neg_hi:[0,1]
    v_pk_fma_f32 v[86:87], v[80:81], v[80:81], v[86:87]
    v_add_f32 v85, v86, v87
    v_pk_add_f32 v[80:81], v[56:57], v[88:89] neg_lo:[0,1] neg_hi:[0,1]
    v_pk_mul_f32 v[90:91], v[80:81], v[80:81]
    v_pk_add_f32 v[80:81], v[58:59], v[88:89] neg_lo:[0,1] neg_hi:[0,1]
    v_pk_fma_f32 v[90:91], v[80:81], v[80:81], v[90:91]
    v_pk_add_f32 v[80:81], v[60:61], v[88:89] neg_lo:[0,1] neg_hi:[0,1]
    v_pk_fma_f32 v[90:91], v[80:81], v[80:81], v[90:91]
    v_pk_add_f32 v[80:81], v[62:63], v[88:89] neg_lo:[0,1] neg_hi:[0,1]
    v_pk_fma_f32 v[90:91], v[80:81], v[80:81], v[90:91]
    v_pk_add_f32 v[80:81], v[64:65], v[88:89] neg_lo:[0,1] neg_hi:[0,1]
    v_pk_fma_f32 v[90:91], v[80:81], v[80:81], v[90:91]
    v_pk_add_f32 v[80:81], v[66:67], v[88:89] neg_lo:[0,1] neg_hi:[0,1]
    v_pk_fma_f32 v[90:91], v[80:81], v[80:81], v[90:91]
    v_pk_add_f32 v[80:81], v[68:69], v[88:89] neg_lo:[0,1] neg_hi:[0,1]
    v_pk_fma_f32 v[90:91], v[80:81], v[80:81], v[90:91]
    v_pk_add_f32 v[80:81], v[70:71], v[88:89] neg_lo:[0,1] neg_hi:[0,1]
    v_pk_fma_f32 v[90:91], v[80:81], v[80:81], v[90:91]
    v_add_f32 v89, v90, v91
    v_mov_b32 v80, v85
    v_mov_b32 v81, v89
    s_nop 1
    v_permlane16_swap_b32 v85, v80
    v_permlane16_swap_b32 v89, v81
    s_nop 1
    v_add_f32 v85, v85, v80
    v_add_f32 v89, v89, v81
    v_mov_b32 v80, v85
    v_mov_b32 v81, v89
    s_nop 1
    v_permlane32_swap_b32 v85, v80
    v_permlane32_swap_b32 v89, v81
    s_nop 1
    v_add_f32 v85, v85, v80
    v_add_f32 v89, v89, v81
    s_lshl_b32 s9, s7, 8
    s_add_u32 s9, s9, 40192
    v_lshlrev_b32 v82, 3, v3
    v_add_u32 v82, s9, v82
    ds_write_b64 v82, v[84:85]
    ds_write_b64 v82, v[88:89] offset:128
    s_waitcnt lgkmcnt(0)
    s_mul_i32 s3, s34, 0x9E3779B1
    s_add_u32 s3, s3, 0x7F4A7C15
    s_lshl_b32 s9, s7, 12
    s_add_u32 s9, s9, 0
    v_add_u32 v120, s9, v1
    s_lshl_b32 s9, s7, 8
    s_add_u32 s9, s9, 36864
    v_lshrrev_b32 v121, 5, v2
    v_lshlrev_b32 v121, 7, v121
    v_and_b32 v122, 31, v2
    v_lshl_add_u32 v121, v122, 1, v121
    v_add_u32 v121, s9, v121
    v_lshlrev_b32 v122, 4, v4
    v_add_u32 v122, s9, v122
    s_barrier
    v_lshlrev_b32 v5, 3, v2
    s_lshl_b32 s9, s7, 9
    s_add_u32 s9, s9, 360448
    s_add_u32 s10, s9, 4608
    s_mov_b32 s11, 262144
    buffer_load_dwordx2 v[112:113], v5, s[12:15], s9 offen sc1
    buffer_load_dwordx2 v[114:115], v5, s[12:15], s10 offen sc1
    v_lshlrev_b32 v7, 3, v3
    v_add_u32 v7, 40192, v7
    ds_read_b64 v[8:9], v7 offset:0
    ds_read_b64 v[10:11], v7 offset:256
    ds_read_b64 v[12:13], v7 offset:512
    ds_read_b64 v[14:15], v7 offset:768
    ds_read_b64 v[16:17], v7 offset:1024
    ds_read_b64 v[18:19], v7 offset:1280
    ds_read_b64 v[20:21], v7 offset:1536
    ds_read_b64 v[22:23], v7 offset:1792
    ds_read_b64 v[24:25], v7 offset:2048
    s_waitcnt lgkmcnt(0)
    v_pk_add_f32 v[72:73], v[8:9], v[10:11]
    v_pk_add_f32 v[72:73], v[72:73], v[12:13]
    v_pk_add_f32 v[72:73], v[72:73], v[14:15]
    v_pk_add_f32 v[72:73], v[72:73], v[16:17]
    v_pk_add_f32 v[72:73], v[72:73], v[18:19]
    v_pk_add_f32 v[72:73], v[72:73], v[20:21]
    v_pk_add_f32 v[72:73], v[72:73], v[22:23]
    v_pk_add_f32 v[72:73], v[72:73], v[24:25]
    v_mul_f32 v72, 0x3de38e39, v72
    v_sub_f32 v74, v8, v72
    v_mul_f32 v75, v74, v74
    v_sub_f32 v74, v10, v72
    v_fmac_f32 v75, v74, v74
    v_sub_f32 v74, v12, v72
    v_fmac_f32 v75, v74, v74
    v_sub_f32 v74, v14, v72
    v_fmac_f32 v75, v74, v74
    v_sub_f32 v74, v16, v72
    v_fmac_f32 v75, v74, v74
    v_sub_f32 v74, v18, v72
    v_fmac_f32 v75, v74, v74
    v_sub_f32 v74, v20, v72
    v_fmac_f32 v75, v74, v74
    v_sub_f32 v74, v22, v72
    v_fmac_f32 v75, v74, v74
    v_sub_f32 v74, v24, v72
    v_fmac_f32 v75, v74, v74
    v_fmac_f32 v73, 0x42800000, v75
    v_mov_b32 v74, 0x3727c5ac
    v_fmac_f32 v74, 0x3ae38e39, v73
    v_rsq_f32 v74, v74
    s_nop 0
    v_mul_f32 v76, v72, v74
    v_pk_fma_f32 v[40:41], v[40:41], v[74:75], v[76:77] op_sel_hi:[1,0,0] neg_lo:[0,0,1] neg_hi:[0,0,1]
    v_pk_fma_f32 v[42:43], v[42:43], v[74:75], v[76:77] op_sel_hi:[1,0,0] neg_lo:[0,0,1] neg_hi:[0,0,1]
    v_pk_fma_f32 v[44:45], v[44:45], v[74:75], v[76:77] op_sel_hi:[1,0,0] neg_lo:[0,0,1] neg_hi:[0,0,1]
    v_pk_fma_f32 v[46:47], v[46:47], v[74:75], v[76:77] op_sel_hi:[1,0,0] neg_lo:[0,0,1] neg_hi:[0,0,1]
    v_pk_fma_f32 v[48:49], v[48:49], v[74:75], v[76:77] op_sel_hi:[1,0,0] neg_lo:[0,0,1] neg_hi:[0,0,1]
    v_pk_fma_f32 v[50:51], v[50:51], v[74:75], v[76:77] op_sel_hi:[1,0,0] neg_lo:[0,0,1] neg_hi:[0,0,1]
    v_pk_fma_f32 v[52:53], v[52:53], v[74:75], v[76:77] op_sel_hi:[1,0,0] neg_lo:[0,0,1] neg_hi:[0,0,1]
    v_pk_fma_f32 v[54:55], v[54:55], v[74:75], v[76:77] op_sel_hi:[1,0,0] neg_lo:[0,0,1] neg_hi:[0,0,1]
    ds_read_b64 v[8:9], v7 offset:128
    ds_read_b64 v[10:11], v7 offset:384
    ds_read_b64 v[12:13], v7 offset:640
    ds_read_b64 v[14:15], v7 offset:896
    ds_read_b64 v[16:17], v7 offset:1152
    ds_read_b64 v[18:19], v7 offset:1408
    ds_read_b64 v[20:21], v7 offset:1664
    ds_read_b64 v[22:23], v7 offset:1920
    ds_read_b64 v[24:25], v7 offset:2176
    s_waitcnt lgkmcnt(0)
    v_pk_add_f32 v[72:73], v[8:9], v[10:11]
    v_pk_add_f32 v[72:73], v[72:73], v[12:13]
    v_pk_add_f32 v[72:73], v[72:73], v[14:15]
    v_pk_add_f32 v[72:73], v[72:73], v[16:17]
    v_pk_add_f32 v[72:73], v[72:73], v[18:19]
    v_pk_add_f32 v[72:73], v[72:73], v[20:21]
    v_pk_add_f32 v[72:73], v[72:73], v[22:23]
    v_pk_add_f32 v[72:73], v[72:73], v[24:25]
    v_mul_f32 v72, 0x3de38e39, v72
    v_sub_f32 v74, v8, v72
    v_mul_f32 v75, v74, v74
    v_sub_f32 v74, v10, v72
    v_fmac_f32 v75, v74, v74
    v_sub_f32 v74, v12, v72
    v_fmac_f32 v75, v74, v74
    v_sub_f32 v74, v14, v72
    v_fmac_f32 v75, v74, v74
    v_sub_f32 v74, v16, v72
    v_fmac_f32 v75, v74, v74
    v_sub_f32 v74, v18, v72
    v_fmac_f32 v75, v74, v74
    v_sub_f32 v74, v20, v72
    v_fmac_f32 v75, v74, v74
    v_sub_f32 v74, v22, v72
    v_fmac_f32 v75, v74, v74
    v_sub_f32 v74, v24, v72
    v_fmac_f32 v75, v74, v74
    v_fmac_f32 v73, 0x42800000, v75
    v_mov_b32 v74, 0x3727c5ac
    v_fmac_f32 v74, 0x3ae38e39, v73
    v_rsq_f32 v74, v74
    s_nop 0
    v_mul_f32 v76, v72, v74
    v_pk_fma_f32 v[56:57], v[56:57], v[74:75], v[76:77] op_sel_hi:[1,0,0] neg_lo:[0,0,1] neg_hi:[0,0,1]
    v_pk_fma_f32 v[58:59], v[58:59], v[74:75], v[76:77] op_sel_hi:[1,0,0] neg_lo:[0,0,1] neg_hi:[0,0,1]
    v_pk_fma_f32 v[60:61], v[60:61], v[74:75], v[76:77] op_sel_hi:[1,0,0] neg_lo:[0,0,1] neg_hi:[0,0,1]
    v_pk_fma_f32 v[62:63], v[62:63], v[74:75], v[76:77] op_sel_hi:[1,0,0] neg_lo:[0,0,1] neg_hi:[0,0,1]
    v_pk_fma_f32 v[64:65], v[64:65], v[74:75], v[76:77] op_sel_hi:[1,0,0] neg_lo:[0,0,1] neg_hi:[0,0,1]
    v_pk_fma_f32 v[66:67], v[66:67], v[74:75], v[76:77] op_sel_hi:[1,0,0] neg_lo:[0,0,1] neg_hi:[0,0,1]
    v_pk_fma_f32 v[68:69], v[68:69], v[74:75], v[76:77] op_sel_hi:[1,0,0] neg_lo:[0,0,1] neg_hi:[0,0,1]
    v_pk_fma_f32 v[70:71], v[70:71], v[74:75], v[76:77] op_sel_hi:[1,0,0] neg_lo:[0,0,1] neg_hi:[0,0,1]
    s_branch L_ka_mc
L_ka_mp:
    buffer_load_dwordx2 v[112:113], v5, s[12:15], s9 offen sc1
    buffer_load_dwordx2 v[114:115], v5, s[12:15], s10 offen sc1
L_ka_mc:
    s_waitcnt vmcnt(0)
    v_xor_b32 v113, s3, v113
    v_xor_b32 v115, s3, v115
    v_or_b32 v113, v113, v115
    v_cmp_ne_u32 vcc, 0, v113
    s_cbranch_vccz L_ka_mk
    s_sleep 4
    s_sub_u32 s11, s11, 1
    s_cmp_lg_u32 s11, 0
    s_cbranch_scc1 L_ka_mp
L_ka_mk:
    ds_write_b16_d16_hi v121, v114
    ds_write_b16_d16_hi v121, v112 offset:64
    s_waitcnt lgkmcnt(0)
    ds_read_b128 v[8:11], v122
    ds_read_b128 v[16:19], v122 offset:64
    ds_read_b128 v[12:15], v122 offset:128
    ds_read_b128 v[20:23], v122 offset:192
    s_waitcnt lgkmcnt(2)
    v_lshlrev_b32 v80, 16, v8
    v_and_b32 v81, 0xffff0000, v8
    v_lshlrev_b32 v24, 16, v16
    v_and_b32 v25, 0xffff0000, v16
    v_lshlrev_b32 v82, 16, v9
    v_and_b32 v83, 0xffff0000, v9
    v_lshlrev_b32 v26, 16, v17
    v_and_b32 v27, 0xffff0000, v17
    v_lshlrev_b32 v84, 16, v10
    v_and_b32 v85, 0xffff0000, v10
    v_lshlrev_b32 v28, 16, v18
    v_and_b32 v29, 0xffff0000, v18
    v_lshlrev_b32 v86, 16, v11
    v_and_b32 v87, 0xffff0000, v11
    v_lshlrev_b32 v30, 16, v19
    v_and_b32 v31, 0xffff0000, v19
    v_pk_fma_f32 v[40:41], v[40:41], v[80:81], v[24:25]
    v_pk_fma_f32 v[42:43], v[42:43], v[82:83], v[26:27]
    v_pk_fma_f32 v[44:45], v[44:45], v[84:85], v[28:29]
    v_pk_fma_f32 v[46:47], v[46:47], v[86:87], v[30:31]
    v_cvt_pk_bf16_f32 v96, v40, v41
    v_cvt_pk_bf16_f32 v97, v42, v43
    v_cvt_pk_bf16_f32 v98, v44, v45
    v_cvt_pk_bf16_f32 v99, v46, v47
    v_pk_fma_f32 v[56:57], v[56:57], v[80:81], v[24:25]
    v_pk_fma_f32 v[58:59], v[58:59], v[82:83], v[26:27]
    v_pk_fma_f32 v[60:61], v[60:61], v[84:85], v[28:29]
    v_pk_fma_f32 v[62:63], v[62:63], v[86:87], v[30:31]
    v_cvt_pk_bf16_f32 v100, v56, v57
    v_cvt_pk_bf16_f32 v101, v58, v59
    v_cvt_pk_bf16_f32 v102, v60, v61
    v_cvt_pk_bf16_f32 v103, v62, v63
    s_waitcnt lgkmcnt(0)
    v_lshlrev_b32 v88, 16, v12
    v_and_b32 v89, 0xffff0000, v12
    v_lshlrev_b32 v32, 16, v20
    v_and_b32 v33, 0xffff0000, v20
    v_lshlrev_b32 v90, 16, v13
    v_and_b32 v91, 0xffff0000, v13
    v_lshlrev_b32 v34, 16, v21
    v_and_b32 v35, 0xffff0000, v21
    v_lshlrev_b32 v92, 16, v14
    v_and_b32 v93, 0xffff0000, v14
    v_lshlrev_b32 v36, 16, v22
    v_and_b32 v37, 0xffff0000, v22
    v_lshlrev_b32 v94, 16, v15
    v_and_b32 v95, 0xffff0000, v15
    v_lshlrev_b32 v38, 16, v23
    v_and_b32 v39, 0xffff0000, v23
    v_pk_fma_f32 v[48:49], v[48:49], v[88:89], v[32:33]
    v_pk_fma_f32 v[50:51], v[50:51], v[90:91], v[34:35]
    v_pk_fma_f32 v[52:53], v[52:53], v[92:93], v[36:37]
    v_pk_fma_f32 v[54:55], v[54:55], v[94:95], v[38:39]
    v_cvt_pk_bf16_f32 v104, v48, v49
    v_cvt_pk_bf16_f32 v105, v50, v51
    v_cvt_pk_bf16_f32 v106, v52, v53
    v_cvt_pk_bf16_f32 v107, v54, v55
    v_pk_fma_f32 v[64:65], v[64:65], v[88:89], v[32:33]
    v_pk_fma_f32 v[66:67], v[66:67], v[90:91], v[34:35]
    v_pk_fma_f32 v[68:69], v[68:69], v[92:93], v[36:37]
    v_pk_fma_f32 v[70:71], v[70:71], v[94:95], v[38:39]
    v_cvt_pk_bf16_f32 v108, v64, v65
    v_cvt_pk_bf16_f32 v109, v66, v67
    v_cvt_pk_bf16_f32 v110, v68, v69
    v_cvt_pk_bf16_f32 v111, v70, v71
    ds_write_b128 v120, v[96:99] offset:0
    ds_write_b128 v120, v[100:103] offset:1024
    ds_write_b128 v120, v[104:107] offset:2048
    ds_write_b128 v120, v[108:111] offset:3072
    s_branch L_ka_b2
L_ka_misc:
    s_cmp_lg_u32 s6, 13
    s_cbranch_scc1 L_ka_dma
    s_cmp_ge_u32 s21, 2
    s_cselect_b32 s16, s30, s28
    s_cselect_b32 s17, s31, s29
    s_mov_b32 s18, 20736
    s_mov_b32 s19, 0x20000
    s_and_b32 s9, s21, 1
    s_lshl_b32 s9, s9, 5
    v_lshrrev_b32 v6, 1, v2
    v_mul_u32_u24 v6, 36, v6
    v_and_b32 v7, 1, v2
    v_lshl_add_u32 v6, v7, 4, v6
    v_add_u32 v6, s9, v6
    v_lshlrev_b32 v7, 8, v4
    v_lshl_add_u32 v7, v3, 3, v7
    v_add_u32 v7, 0, v7
    s_mul_i32 s10, s20, 2368
    s_add_u32 s10, s10, 23068672
    v_lshlrev_b32 v80, 7, v2
    v_add_u32 v80, s10, v80
    s_lshl_b32 s10, s20, 7
    s_add_u32 s10, s10, 270336
    v_mov_b32 v81, s10
    v_cmp_gt_u32 vcc, 20, v2
    s_nop 1
    v_cndmask_b32 v80, v81, v80, vcc
    s_mov_b64 exec, 0x1fffff
    buffer_load_dword v82, v80, s[12:15], 0 offen sc1
    s_mov_b64 exec, -1
    s_mov_b32 m0, 0
    s_nop 0
    buffer_load_dwordx4 v6, s[16:19], 0 offen lds
    v_add_u32 v6, 1152, v6
    s_mov_b32 m0, 1024
    s_nop 0
    buffer_load_dwordx4 v6, s[16:19], 0 offen lds
    v_add_u32 v6, 1152, v6
    s_mov_b32 m0, 2048
    s_nop 0
    buffer_load_dwordx4 v6, s[16:19], 0 offen lds
    v_add_u32 v6, 1152, v6
    s_mov_b32 m0, 3072
    s_nop 0
    buffer_load_dwordx4 v6, s[16:19], 0 offen lds
    v_add_u32 v6, 1152, v6
    s_mov_b32 m0, 4096
    s_nop 0
    buffer_load_dwordx4 v6, s[16:19], 0 offen lds
    v_add_u32 v6, 1152, v6
    s_mov_b32 m0, 5120
    s_nop 0
    buffer_load_dwordx4 v6, s[16:19], 0 offen lds
    v_add_u32 v6, 1152, v6
    s_mov_b32 m0, 6144
    s_nop 0
    buffer_load_dwordx4 v6, s[16:19], 0 offen lds
    v_add_u32 v6, 1152, v6
    s_mov_b32 m0, 7168
    s_nop 0
    buffer_load_dwordx4 v6, s[16:19], 0 offen lds
    v_add_u32 v6, 1152, v6
    s_mov_b32 m0, 8192
    s_nop 0
    buffer_load_dwordx4 v6, s[16:19], 0 offen lds
    v_add_u32 v6, 1152, v6
    s_mov_b32 m0, 9216
    s_nop 0
    buffer_load_dwordx4 v6, s[16:19], 0 offen lds
    v_add_u32 v6, 1152, v6
    s_mov_b32 m0, 10240
    s_nop 0
    buffer_load_dwordx4 v6, s[16:19], 0 offen lds
    v_add_u32 v6, 1152, v6
    s_mov_b32 m0, 11264
    s_nop 0
    buffer_load_dwordx4 v6, s[16:19], 0 offen lds
    v_add_u32 v6, 1152, v6
    s_mov_b32 m0, 12288
    s_nop 0
    buffer_load_dwordx4 v6, s[16:19], 0 offen lds
    v_add_u32 v6, 1152, v6
    s_mov_b32 m0, 13312
    s_nop 0
    buffer_load_dwordx4 v6, s[16:19], 0 offen lds
    v_add_u32 v6, 1152, v6
    s_mov_b32 m0, 14336
    s_nop 0
    buffer_load_dwordx4 v6, s[16:19], 0 offen lds
    v_add_u32 v6, 1152, v6
    s_mov_b32 m0, 15360
    s_nop 0
    buffer_load_dwordx4 v6, s[16:19], 0 offen lds
    v_add_u32 v6, 1152, v6
    s_mov_b32 m0, 16384
    s_nop 0
    buffer_load_dwordx4 v6, s[16:19], 0 offen lds
    v_add_u32 v6, 1152, v6
    s_mov_b32 m0, 17408
    s_nop 0
    buffer_load_dwordx4 v6, s[16:19], 0 offen lds
    v_add_u32 v6, 1152, v6
    s_waitcnt vmcnt(0)
    ds_read_b64_tr_b16 v[8:9], v7 offset:0
    ds_read_b64_tr_b16 v[10:11], v7 offset:128
    ds_read_b64_tr_b16 v[12:13], v7 offset:1024
    ds_read_b64_tr_b16 v[14:15], v7 offset:1152
    ds_read_b64_tr_b16 v[16:17], v7 offset:2048
    ds_read_b64_tr_b16 v[18:19], v7 offset:2176
    ds_read_b64_tr_b16 v[20:21], v7 offset:3072
    ds_read_b64_tr_b16 v[22:23], v7 offset:3200
    ds_read_b64_tr_b16 v[24:25], v7 offset:4096
    ds_read_b64_tr_b16 v[26:27], v7 offset:4224
    ds_read_b64_tr_b16 v[28:29], v7 offset:5120
    ds_read_b64_tr_b16 v[30:31], v7 offset:5248
    ds_read_b64_tr_b16 v[32:33], v7 offset:6144
    ds_read_b64_tr_b16 v[34:35], v7 offset:6272
    ds_read_b64_tr_b16 v[36:37], v7 offset:7168
    ds_read_b64_tr_b16 v[38:39], v7 offset:7296
    ds_read_b64_tr_b16 v[40:41], v7 offset:8192
    ds_read_b64_tr_b16 v[42:43], v7 offset:8320
    ds_read_b64_tr_b16 v[44:45], v7 offset:9216
    ds_read_b64_tr_b16 v[46:47], v7 offset:9344
    ds_read_b64_tr_b16 v[48:49], v7 offset:10240
    ds_read_b64_tr_b16 v[50:51], v7 offset:10368
    ds_read_b64_tr_b16 v[52:53], v7 offset:11264
    ds_read_b64_tr_b16 v[54:55], v7 offset:11392
    ds_read_b64_tr_b16 v[56:57], v7 offset:12288
    ds_read_b64_tr_b16 v[58:59], v7 offset:12416
    ds_read_b64_tr_b16 v[60:61], v7 offset:13312
    ds_read_b64_tr_b16 v[62:63], v7 offset:13440
    ds_read_b64_tr_b16 v[64:65], v7 offset:14336
    ds_read_b64_tr_b16 v[66:67], v7 offset:14464
    ds_read_b64_tr_b16 v[68:69], v7 offset:15360
    ds_read_b64_tr_b16 v[70:71], v7 offset:15488
    ds_read_b64_tr_b16 v[72:73], v7 offset:16384
    ds_read_b64_tr_b16 v[74:75], v7 offset:16512
    ds_read_b64_tr_b16 v[76:77], v7 offset:17408
    ds_read_b64_tr_b16 v[78:79], v7 offset:17536
    s_waitcnt lgkmcnt(0)
    s_barrier
    s_mul_i32 s3, s34, 0x9E3779B1
    s_add_u32 s3, s3, 0x7F4A7C15
    s_setprio 3
    s_barrier
    s_branch L_ka_gemm13
L_ka_dma:
    s_mov_b32 s44, s26
    s_mov_b32 s45, s27
    s_mov_b32 s46, 663552
    s_mov_b32 s47, 0x20000
    s_lshr_b32 s9, s63, 5
    s_mul_i32 s9, s9, 72
    v_mul_u32_u24 v5, 21846, v2
    v_lshrrev_b32 v5, 16, v5
    v_mul_u32_u24 v6, 3, v5
    v_sub_u32 v6, v2, v6
    v_add_u32 v5, s9, v5
    v_mul_u32_u24 v5, 1152, v5
    v_lshl_add_u32 v5, v6, 7, v5
    s_mul_i32 s10, s21, 288
    s_cmp_lg_u32 s6, 14
    s_cbranch_scc1 L_ka_nt
    buffer_load_dword v30, v5, s[44:47], s10 offen
    v_add_u32 v5, 20736, v5
    buffer_load_dword v30, v5, s[44:47], s10 offen
    v_add_u32 v5, 20736, v5
    buffer_load_dword v30, v5, s[44:47], s10 offen
    v_add_u32 v5, 20736, v5
    buffer_load_dword v30, v5, s[44:47], s10 offen
    s_branch L_ka_nt2
L_ka_nt:
    s_lshr_b32 s9, s63, 3
    s_getpc_b64 s[48:49]
L_adaLN_cond__grouped_kv_mqa__dense_activation_relu__prompt_kernel_pc_1:
    s_add_u32 s48, s48, L_ka_b1-L_adaLN_cond__grouped_kv_mqa__dense_activation_relu__prompt_kernel_pc_1
    s_addc_u32 s49, s49, 0
    s_mov_b32 s50, L_kb_codeend-L_ka_b1
    s_mov_b32 s51, 0x20000
    s_lshl_b32 s52, s9, 11
    v_lshlrev_b32 v5, 5, v2
    v_add_u32 v5, s52, v5
    buffer_load_dword v30, v5, s[48:51], 0 offen
L_ka_nt2:
    v_add_u32 v5, 0, v2
    v_mul_u32_u24 v7, 3641, v5
    v_lshrrev_b32 v7, 16, v7
    v_mul_u32_u24 v6, 18, v7
    v_sub_u32 v5, v5, v6
    v_mul_u32_u24 v7, 1152, v7
    v_lshl_add_u32 v16, v5, 4, v7
    v_add_u32 v5, 64, v2
    v_mul_u32_u24 v7, 3641, v5
    v_lshrrev_b32 v7, 16, v7
    v_mul_u32_u24 v6, 18, v7
    v_sub_u32 v5, v5, v6
    v_mul_u32_u24 v7, 1152, v7
    v_lshl_add_u32 v17, v5, 4, v7
    v_add_u32 v5, 128, v2
    v_mul_u32_u24 v7, 3641, v5
    v_lshrrev_b32 v7, 16, v7
    v_mul_u32_u24 v6, 18, v7
    v_sub_u32 v5, v5, v6
    v_mul_u32_u24 v7, 1152, v7
    v_lshl_add_u32 v18, v5, 4, v7
    v_add_u32 v5, 192, v2
    v_mul_u32_u24 v7, 3641, v5
    v_lshrrev_b32 v7, 16, v7
    v_mul_u32_u24 v6, 18, v7
    v_sub_u32 v5, v5, v6
    v_mul_u32_u24 v7, 1152, v7
    v_lshl_add_u32 v19, v5, 4, v7
    v_add_u32 v5, 256, v2
    v_mul_u32_u24 v7, 3641, v5
    v_lshrrev_b32 v7, 16, v7
    v_mul_u32_u24 v6, 18, v7
    v_sub_u32 v5, v5, v6
    v_mul_u32_u24 v7, 1152, v7
    v_lshl_add_u32 v20, v5, 4, v7
    v_add_u32 v5, 320, v2
    v_mul_u32_u24 v7, 3641, v5
    v_lshrrev_b32 v7, 16, v7
    v_mul_u32_u24 v6, 18, v7
    v_sub_u32 v5, v5, v6
    v_mul_u32_u24 v7, 1152, v7
    v_lshl_add_u32 v21, v5, 4, v7
    v_add_u32 v5, 384, v2
    v_mul_u32_u24 v7, 3641, v5
    v_lshrrev_b32 v7, 16, v7
    v_mul_u32_u24 v6, 18, v7
    v_sub_u32 v5, v5, v6
    v_mul_u32_u24 v7, 1152, v7
    v_lshl_add_u32 v22, v5, 4, v7
    v_add_u32 v5, 448, v2
    v_mul_u32_u24 v7, 3641, v5
    v_lshrrev_b32 v7, 16, v7
    v_mul_u32_u24 v6, 18, v7
    v_sub_u32 v5, v5, v6
    v_mul_u32_u24 v7, 1152, v7
    v_lshl_add_u32 v23, v5, 4, v7
    v_add_u32 v5, 512, v2
    v_mul_u32_u24 v7, 3641, v5
    v_lshrrev_b32 v7, 16, v7
    v_mul_u32_u24 v6, 18, v7
    v_sub_u32 v5, v5, v6
    v_mul_u32_u24 v7, 1152, v7
    v_lshl_add_u32 v24, v5, 4, v7
    s_sub_u32 s9, s6, 14
    s_mul_i32 s11, s9, 9216
    s_add_u32 s11, s11, 43008
    s_mul_i32 s9, s9, 36864
    s_add_u32 s10, s10, s9
    s_mov_b32 m0, s11
    s_add_u32 s11, s11, 1024
    buffer_load_dwordx4 v16, s[44:47], s10 offen lds
    s_mov_b32 m0, s11
    s_add_u32 s11, s11, 1024
    buffer_load_dwordx4 v17, s[44:47], s10 offen lds
    s_mov_b32 m0, s11
    s_add_u32 s11, s11, 1024
    buffer_load_dwordx4 v18, s[44:47], s10 offen lds
    s_mov_b32 m0, s11
    s_add_u32 s11, s11, 1024
    buffer_load_dwordx4 v19, s[44:47], s10 offen lds
    s_mov_b32 m0, s11
    s_add_u32 s11, s11, 1024
    buffer_load_dwordx4 v20, s[44:47], s10 offen lds
    s_mov_b32 m0, s11
    s_add_u32 s11, s11, 1024
    buffer_load_dwordx4 v21, s[44:47], s10 offen lds
    s_mov_b32 m0, s11
    s_add_u32 s11, s11, 1024
    buffer_load_dwordx4 v22, s[44:47], s10 offen lds
    s_mov_b32 m0, s11
    s_add_u32 s11, s11, 1024
    buffer_load_dwordx4 v23, s[44:47], s10 offen lds
    s_mov_b32 m0, s11
    s_add_u32 s11, s11, 1024
    buffer_load_dwordx4 v24, s[44:47], s10 offen lds
    s_add_u32 s10, s10, 73728
    s_add_u32 s11, s11, 9216
    s_mov_b32 m0, s11
    s_add_u32 s11, s11, 1024
    buffer_load_dwordx4 v16, s[44:47], s10 offen lds
    s_mov_b32 m0, s11
    s_add_u32 s11, s11, 1024
    buffer_load_dwordx4 v17, s[44:47], s10 offen lds
    s_mov_b32 m0, s11
    s_add_u32 s11, s11, 1024
    buffer_load_dwordx4 v18, s[44:47], s10 offen lds
    s_mov_b32 m0, s11
    s_add_u32 s11, s11, 1024
    buffer_load_dwordx4 v19, s[44:47], s10 offen lds
    s_mov_b32 m0, s11
    s_add_u32 s11, s11, 1024
    buffer_load_dwordx4 v20, s[44:47], s10 offen lds
    s_mov_b32 m0, s11
    s_add_u32 s11, s11, 1024
    buffer_load_dwordx4 v21, s[44:47], s10 offen lds
    s_mov_b32 m0, s11
    s_add_u32 s11, s11, 1024
    buffer_load_dwordx4 v22, s[44:47], s10 offen lds
    s_mov_b32 m0, s11
    s_add_u32 s11, s11, 1024
    buffer_load_dwordx4 v23, s[44:47], s10 offen lds
    s_mov_b32 m0, s11
    s_add_u32 s11, s11, 1024
    buffer_load_dwordx4 v24, s[44:47], s10 offen lds
    s_add_u32 s10, s10, 73728
    s_add_u32 s11, s11, 9216
    s_mov_b32 m0, s11
    s_add_u32 s11, s11, 1024
    buffer_load_dwordx4 v16, s[44:47], s10 offen lds
    s_mov_b32 m0, s11
    s_add_u32 s11, s11, 1024
    buffer_load_dwordx4 v17, s[44:47], s10 offen lds
    s_mov_b32 m0, s11
    s_add_u32 s11, s11, 1024
    buffer_load_dwordx4 v18, s[44:47], s10 offen lds
    s_mov_b32 m0, s11
    s_add_u32 s11, s11, 1024
    buffer_load_dwordx4 v19, s[44:47], s10 offen lds
    s_mov_b32 m0, s11
    s_add_u32 s11, s11, 1024
    buffer_load_dwordx4 v20, s[44:47], s10 offen lds
    s_mov_b32 m0, s11
    s_add_u32 s11, s11, 1024
    buffer_load_dwordx4 v21, s[44:47], s10 offen lds
    s_mov_b32 m0, s11
    s_add_u32 s11, s11, 1024
    buffer_load_dwordx4 v22, s[44:47], s10 offen lds
    s_mov_b32 m0, s11
    s_add_u32 s11, s11, 1024
    buffer_load_dwordx4 v23, s[44:47], s10 offen lds
    s_mov_b32 m0, s11
    s_add_u32 s11, s11, 1024
    buffer_load_dwordx4 v24, s[44:47], s10 offen lds
    s_add_u32 s10, s10, 73728
    s_add_u32 s11, s11, 9216
    s_mov_b32 m0, s11
    s_add_u32 s11, s11, 1024
    buffer_load_dwordx4 v16, s[44:47], s10 offen lds
    s_mov_b32 m0, s11
    s_add_u32 s11, s11, 1024
    buffer_load_dwordx4 v17, s[44:47], s10 offen lds
    s_mov_b32 m0, s11
    s_add_u32 s11, s11, 1024
    buffer_load_dwordx4 v18, s[44:47], s10 offen lds
    s_mov_b32 m0, s11
    s_add_u32 s11, s11, 1024
    buffer_load_dwordx4 v19, s[44:47], s10 offen lds
    s_mov_b32 m0, s11
    s_add_u32 s11, s11, 1024
    buffer_load_dwordx4 v20, s[44:47], s10 offen lds
    s_mov_b32 m0, s11
    s_add_u32 s11, s11, 1024
    buffer_load_dwordx4 v21, s[44:47], s10 offen lds
    s_mov_b32 m0, s11
    s_add_u32 s11, s11, 1024
    buffer_load_dwordx4 v22, s[44:47], s10 offen lds
    s_mov_b32 m0, s11
    s_add_u32 s11, s11, 1024
    buffer_load_dwordx4 v23, s[44:47], s10 offen lds
    s_mov_b32 m0, s11
    s_add_u32 s11, s11, 1024
    buffer_load_dwordx4 v24, s[44:47], s10 offen lds
    s_add_u32 s10, s10, 73728
    s_add_u32 s11, s11, 9216
    s_barrier
    s_mov_b32 m0, s11
    s_add_u32 s11, s11, 1024
    buffer_load_dwordx4 v16, s[44:47], s10 offen lds
    s_mov_b32 m0, s11
    s_add_u32 s11, s11, 1024
    buffer_load_dwordx4 v17, s[44:47], s10 offen lds
    s_mov_b32 m0, s11
    s_add_u32 s11, s11, 1024
    buffer_load_dwordx4 v18, s[44:47], s10 offen lds
    s_mov_b32 m0, s11
    s_add_u32 s11, s11, 1024
    buffer_load_dwordx4 v19, s[44:47], s10 offen lds
    s_mov_b32 m0, s11
    s_add_u32 s11, s11, 1024
    buffer_load_dwordx4 v20, s[44:47], s10 offen lds
    s_mov_b32 m0, s11
    s_add_u32 s11, s11, 1024
    buffer_load_dwordx4 v21, s[44:47], s10 offen lds
    s_mov_b32 m0, s11
    s_add_u32 s11, s11, 1024
    buffer_load_dwordx4 v22, s[44:47], s10 offen lds
    s_mov_b32 m0, s11
    s_add_u32 s11, s11, 1024
    buffer_load_dwordx4 v23, s[44:47], s10 offen lds
    s_mov_b32 m0, s11
    s_add_u32 s11, s11, 1024
    buffer_load_dwordx4 v24, s[44:47], s10 offen lds
    s_add_u32 s10, s10, 73728
    s_add_u32 s11, s11, 9216
    s_mov_b32 m0, s11
    s_add_u32 s11, s11, 1024
    buffer_load_dwordx4 v16, s[44:47], s10 offen lds
    s_mov_b32 m0, s11
    s_add_u32 s11, s11, 1024
    buffer_load_dwordx4 v17, s[44:47], s10 offen lds
    s_mov_b32 m0, s11
    s_add_u32 s11, s11, 1024
    buffer_load_dwordx4 v18, s[44:47], s10 offen lds
    s_mov_b32 m0, s11
    s_add_u32 s11, s11, 1024
    buffer_load_dwordx4 v19, s[44:47], s10 offen lds
    s_mov_b32 m0, s11
    s_add_u32 s11, s11, 1024
    buffer_load_dwordx4 v20, s[44:47], s10 offen lds
    s_mov_b32 m0, s11
    s_add_u32 s11, s11, 1024
    buffer_load_dwordx4 v21, s[44:47], s10 offen lds
    s_mov_b32 m0, s11
    s_add_u32 s11, s11, 1024
    buffer_load_dwordx4 v22, s[44:47], s10 offen lds
    s_mov_b32 m0, s11
    s_add_u32 s11, s11, 1024
    buffer_load_dwordx4 v23, s[44:47], s10 offen lds
    s_mov_b32 m0, s11
    s_add_u32 s11, s11, 1024
    buffer_load_dwordx4 v24, s[44:47], s10 offen lds
    s_add_u32 s10, s10, 73728
    s_add_u32 s11, s11, 9216
    s_cmp_lg_u32 s6, 14
    s_cbranch_scc1 L_ka_d1
    s_mov_b32 m0, s11
    s_add_u32 s11, s11, 1024
    buffer_load_dwordx4 v16, s[44:47], s10 offen lds
    s_mov_b32 m0, s11
    s_add_u32 s11, s11, 1024
    buffer_load_dwordx4 v17, s[44:47], s10 offen lds
    s_mov_b32 m0, s11
    s_add_u32 s11, s11, 1024
    buffer_load_dwordx4 v18, s[44:47], s10 offen lds
    s_mov_b32 m0, s11
    s_add_u32 s11, s11, 1024
    buffer_load_dwordx4 v19, s[44:47], s10 offen lds
    s_mov_b32 m0, s11
    s_add_u32 s11, s11, 1024
    buffer_load_dwordx4 v20, s[44:47], s10 offen lds
    s_mov_b32 m0, s11
    s_add_u32 s11, s11, 1024
    buffer_load_dwordx4 v21, s[44:47], s10 offen lds
    s_mov_b32 m0, s11
    s_add_u32 s11, s11, 1024
    buffer_load_dwordx4 v22, s[44:47], s10 offen lds
    s_mov_b32 m0, s11
    s_add_u32 s11, s11, 1024
    buffer_load_dwordx4 v23, s[44:47], s10 offen lds
    s_mov_b32 m0, s11
    s_add_u32 s11, s11, 1024
    buffer_load_dwordx4 v24, s[44:47], s10 offen lds
    s_add_u32 s10, s10, 73728
    s_add_u32 s11, s11, 9216
L_ka_d1:
    s_sub_u32 s11, s11, 119808
    s_waitcnt vmcnt(0) lgkmcnt(0)
    s_mul_i32 s3, s34, 0x9E3779B1
    s_add_u32 s3, s3, 0x7F4A7C15
    s_barrier
    s_barrier
    s_mov_b32 m0, s11
    s_add_u32 s11, s11, 1024
    buffer_load_dwordx4 v16, s[44:47], s10 offen lds
    s_mov_b32 m0, s11
    s_add_u32 s11, s11, 1024
    buffer_load_dwordx4 v17, s[44:47], s10 offen lds
    s_mov_b32 m0, s11
    s_add_u32 s11, s11, 1024
    buffer_load_dwordx4 v18, s[44:47], s10 offen lds
    s_mov_b32 m0, s11
    s_add_u32 s11, s11, 1024
    buffer_load_dwordx4 v19, s[44:47], s10 offen lds
    s_mov_b32 m0, s11
    s_add_u32 s11, s11, 1024
    buffer_load_dwordx4 v20, s[44:47], s10 offen lds
    s_mov_b32 m0, s11
    s_add_u32 s11, s11, 1024
    buffer_load_dwordx4 v21, s[44:47], s10 offen lds
    s_mov_b32 m0, s11
    s_add_u32 s11, s11, 1024
    buffer_load_dwordx4 v22, s[44:47], s10 offen lds
    s_mov_b32 m0, s11
    s_add_u32 s11, s11, 1024
    buffer_load_dwordx4 v23, s[44:47], s10 offen lds
    s_mov_b32 m0, s11
    s_add_u32 s11, s11, 1024
    buffer_load_dwordx4 v24, s[44:47], s10 offen lds
    s_add_u32 s10, s10, 73728
    s_add_u32 s11, s11, 9216
    s_mov_b32 m0, s11
    s_add_u32 s11, s11, 1024
    buffer_load_dwordx4 v16, s[44:47], s10 offen lds
    s_mov_b32 m0, s11
    s_add_u32 s11, s11, 1024
    buffer_load_dwordx4 v17, s[44:47], s10 offen lds
    s_mov_b32 m0, s11
    s_add_u32 s11, s11, 1024
    buffer_load_dwordx4 v18, s[44:47], s10 offen lds
    s_mov_b32 m0, s11
    s_add_u32 s11, s11, 1024
    buffer_load_dwordx4 v19, s[44:47], s10 offen lds
    s_mov_b32 m0, s11
    s_add_u32 s11, s11, 1024
    buffer_load_dwordx4 v20, s[44:47], s10 offen lds
    s_mov_b32 m0, s11
    s_add_u32 s11, s11, 1024
    buffer_load_dwordx4 v21, s[44:47], s10 offen lds
    s_mov_b32 m0, s11
    s_add_u32 s11, s11, 1024
    buffer_load_dwordx4 v22, s[44:47], s10 offen lds
    s_mov_b32 m0, s11
    s_add_u32 s11, s11, 1024
    buffer_load_dwordx4 v23, s[44:47], s10 offen lds
    s_mov_b32 m0, s11
    s_add_u32 s11, s11, 1024
    buffer_load_dwordx4 v24, s[44:47], s10 offen lds
    s_add_u32 s10, s10, 73728
    s_add_u32 s11, s11, 9216
    s_cmp_lg_u32 s6, 15
    s_cbranch_scc1 L_ka_d2
    s_mov_b32 m0, s11
    s_add_u32 s11, s11, 1024
    buffer_load_dwordx4 v16, s[44:47], s10 offen lds
    s_mov_b32 m0, s11
    s_add_u32 s11, s11, 1024
    buffer_load_dwordx4 v17, s[44:47], s10 offen lds
    s_mov_b32 m0, s11
    s_add_u32 s11, s11, 1024
    buffer_load_dwordx4 v18, s[44:47], s10 offen lds
    s_mov_b32 m0, s11
    s_add_u32 s11, s11, 1024
    buffer_load_dwordx4 v19, s[44:47], s10 offen lds
    s_mov_b32 m0, s11
    s_add_u32 s11, s11, 1024
    buffer_load_dwordx4 v20, s[44:47], s10 offen lds
    s_mov_b32 m0, s11
    s_add_u32 s11, s11, 1024
    buffer_load_dwordx4 v21, s[44:47], s10 offen lds
    s_mov_b32 m0, s11
    s_add_u32 s11, s11, 1024
    buffer_load_dwordx4 v22, s[44:47], s10 offen lds
    s_mov_b32 m0, s11
    s_add_u32 s11, s11, 1024
    buffer_load_dwordx4 v23, s[44:47], s10 offen lds
    s_mov_b32 m0, s11
    s_add_u32 s11, s11, 1024
    buffer_load_dwordx4 v24, s[44:47], s10 offen lds
    s_add_u32 s10, s10, 73728
    s_add_u32 s11, s11, 9216
L_ka_d2:
    s_waitcnt vmcnt(0)
    s_barrier
    s_branch L_ka_bq
L_ka_b1:
    s_waitcnt lgkmcnt(0)
    s_mul_i32 s3, s34, 0x9E3779B1
    s_add_u32 s3, s3, 0x7F4A7C15
    s_barrier
L_ka_nost:
    s_waitcnt vmcnt(0)
L_ka_b2:
    s_waitcnt lgkmcnt(0)
    s_barrier
    s_cmp_lt_u32 s6, 9
    s_cbranch_scc1 L_ka_g0
    s_min_u32 s52, s2, 215
    s_mul_i32 s9, s52, 5462
    s_lshr_b32 s9, s9, 16
    s_mul_i32 s10, s9, 12
    s_sub_u32 s10, s52, s10
    s_mul_i32 s10, s10, 3
    v_mul_u32_u24 v5, 9216, v4
    v_lshl_add_u32 v5, v3, 1, v5
    s_mul_i32 s11, s9, 36864
    s_lshl_b32 s42, s10, 5
    s_add_u32 s11, s11, s42
    s_add_u32 s42, s11, 4608
    s_mul_i32 s43, s10, 18
    s_add_u32 s43, s43, s9
    s_lshl_b32 s43, s43, 10
    s_add_u32 s43, s43, 2097152
    s_mov_b32 s16, s32
    s_mov_b32 s17, s33
    s_mov_b32 s18, 663552
    s_mov_b32 s19, 0x20000
    s_cmp_lg_u32 s6, 10
    s_cbranch_scc1 L_ka_now
    buffer_load_ushort v80, v5, s[16:19], s11 offen offset:0
    buffer_load_ushort v81, v5, s[16:19], s11 offen offset:1152
    buffer_load_ushort v82, v5, s[16:19], s11 offen offset:2304
    buffer_load_ushort v83, v5, s[16:19], s11 offen offset:3456
    buffer_load_ushort v84, v5, s[16:19], s42 offen offset:0
    buffer_load_ushort v85, v5, s[16:19], s42 offen offset:1152
    buffer_load_ushort v86, v5, s[16:19], s42 offen offset:2304
    buffer_load_ushort v87, v5, s[16:19], s42 offen offset:3456
    buffer_load_ushort v88, v5, s[16:19], s11 offen offset:32
    buffer_load_ushort v89, v5, s[16:19], s11 offen offset:1184
    buffer_load_ushort v90, v5, s[16:19], s11 offen offset:2336
    buffer_load_ushort v91, v5, s[16:19], s11 offen offset:3488
    buffer_load_ushort v92, v5, s[16:19], s42 offen offset:32
    buffer_load_ushort v93, v5, s[16:19], s42 offen offset:1184
    buffer_load_ushort v94, v5, s[16:19], s42 offen offset:2336
    buffer_load_ushort v95, v5, s[16:19], s42 offen offset:3488
    buffer_load_ushort v96, v5, s[16:19], s11 offen offset:64
    buffer_load_ushort v97, v5, s[16:19], s11 offen offset:1216
    buffer_load_ushort v98, v5, s[16:19], s11 offen offset:2368
    buffer_load_ushort v99, v5, s[16:19], s11 offen offset:3520
    buffer_load_ushort v100, v5, s[16:19], s42 offen offset:64
    buffer_load_ushort v101, v5, s[16:19], s42 offen offset:1216
    buffer_load_ushort v102, v5, s[16:19], s42 offen offset:2368
    buffer_load_ushort v103, v5, s[16:19], s42 offen offset:3520
L_ka_now:
    s_barrier
    s_barrier
    s_cmp_lg_u32 s6, 9
    s_cbranch_scc1 L_ka_nop
    v_mov_b32 v80, -1
    v_mov_b32 v81, -1
    v_mov_b32 v82, -1
    v_mov_b32 v83, -1
    s_mul_i32 s10, s2, 9216
    s_add_u32 s11, s10, 30408704
    s_add_u32 s10, s10, 24117248
    buffer_store_dwordx4 v[80:83], v1, s[12:15], s10 offen offset:0 sc1
    buffer_store_dwordx4 v[80:83], v1, s[12:15], s11 offen offset:0 sc1
    buffer_store_dwordx4 v[80:83], v1, s[12:15], s10 offen offset:1024 sc1
    buffer_store_dwordx4 v[80:83], v1, s[12:15], s11 offen offset:1024 sc1
    buffer_store_dwordx4 v[80:83], v1, s[12:15], s10 offen offset:2048 sc1
    buffer_store_dwordx4 v[80:83], v1, s[12:15], s11 offen offset:2048 sc1
    buffer_store_dwordx4 v[80:83], v1, s[12:15], s10 offen offset:3072 sc1
    buffer_store_dwordx4 v[80:83], v1, s[12:15], s11 offen offset:3072 sc1
    s_add_u32 s10, s10, 4096
    s_add_u32 s11, s11, 4096
    buffer_store_dwordx4 v[80:83], v1, s[12:15], s10 offen offset:0 sc1
    buffer_store_dwordx4 v[80:83], v1, s[12:15], s11 offen offset:0 sc1
    buffer_store_dwordx4 v[80:83], v1, s[12:15], s10 offen offset:1024 sc1
    buffer_store_dwordx4 v[80:83], v1, s[12:15], s11 offen offset:1024 sc1
    buffer_store_dwordx4 v[80:83], v1, s[12:15], s10 offen offset:2048 sc1
    buffer_store_dwordx4 v[80:83], v1, s[12:15], s11 offen offset:2048 sc1
    buffer_store_dwordx4 v[80:83], v1, s[12:15], s10 offen offset:3072 sc1
    buffer_store_dwordx4 v[80:83], v1, s[12:15], s11 offen offset:3072 sc1
    s_add_u32 s10, s10, 4096
    s_add_u32 s11, s11, 4096
    buffer_store_dwordx4 v[80:83], v1, s[12:15], s10 offen offset:0 sc1
    buffer_store_dwordx4 v[80:83], v1, s[12:15], s11 offen offset:0 sc1
    s_lshl_b32 s10, s2, 8
    s_add_u32 s10, s10, 196608
    s_mov_b64 exec, 0xffff
    buffer_store_dwordx4 v[80:83], v1, s[12:15], s10 offen sc1
    s_mov_b64 exec, -1
    s_waitcnt lgkmcnt(0)
    s_barrier
    s_branch L_ka_bq2
L_ka_nop:
    s_cmp_lg_u32 s6, 10
    s_cbranch_scc1 L_ka_now2
    s_waitcnt vmcnt(0)
    v_lshl_or_b32 v104, v81, 16, v80
    v_lshl_or_b32 v105, v83, 16, v82
    v_lshl_or_b32 v106, v85, 16, v84
    v_lshl_or_b32 v107, v87, 16, v86
    buffer_store_dwordx4 v[104:107], v1, s[12:15], s43 offen sc1
    s_add_u32 s43, s43, 18432
    v_lshl_or_b32 v108, v89, 16, v88
    v_lshl_or_b32 v109, v91, 16, v90
    v_lshl_or_b32 v110, v93, 16, v92
    v_lshl_or_b32 v111, v95, 16, v94
    buffer_store_dwordx4 v[108:111], v1, s[12:15], s43 offen sc1
    s_add_u32 s43, s43, 18432
    v_lshl_or_b32 v112, v97, 16, v96
    v_lshl_or_b32 v113, v99, 16, v98
    v_lshl_or_b32 v114, v101, 16, v100
    v_lshl_or_b32 v115, v103, 16, v102
    buffer_store_dwordx4 v[112:115], v1, s[12:15], s43 offen sc1
L_ka_now2:
    s_branch L_ka_bq
L_ka_gemm13:
    v_add_u32 v5, 0, v1
    v_and_b32 v2, 1, v3
    v_lshlrev_b32 v2, 6, v2
    v_lshl_add_u32 v2, v4, 4, v2
    v_add_u32 v2, 36864, v2
    ds_read_b128 v[80:83], v5 offset:0
    ds_read_b128 v[84:87], v5 offset:1024
    ds_read_b128 v[88:91], v5 offset:2048
    ds_read_b128 v[92:95], v5 offset:3072
    ds_read_b128 v[96:99], v5 offset:4096
    ds_read_b128 v[100:103], v5 offset:5120
    ds_read_b128 v[104:107], v5 offset:6144
    ds_read_b128 v[108:111], v5 offset:7168
    s_waitcnt lgkmcnt(6)
    v_mfma_f32_16x16x32_bf16 v[116:119], v[8:11], v[80:83], 0
    v_mfma_f32_16x16x32_bf16 v[120:123], v[8:11], v[84:87], 0
    ds_read_b128 v[80:83], v5 offset:8192
    ds_read_b128 v[84:87], v5 offset:9216
    s_waitcnt lgkmcnt(6)
    v_mfma_f32_16x16x32_bf16 v[116:119], v[12:15], v[88:91], v[116:119]
    v_mfma_f32_16x16x32_bf16 v[120:123], v[12:15], v[92:95], v[120:123]
    ds_read_b128 v[88:91], v5 offset:10240
    ds_read_b128 v[92:95], v5 offset:11264
    s_waitcnt lgkmcnt(6)
    v_mfma_f32_16x16x32_bf16 v[116:119], v[16:19], v[96:99], v[116:119]
    v_mfma_f32_16x16x32_bf16 v[120:123], v[16:19], v[100:103], v[120:123]
    ds_read_b128 v[96:99], v5 offset:12288
    ds_read_b128 v[100:103], v5 offset:13312
    s_waitcnt lgkmcnt(6)
    v_mfma_f32_16x16x32_bf16 v[116:119], v[20:23], v[104:107], v[116:119]
    v_mfma_f32_16x16x32_bf16 v[120:123], v[20:23], v[108:111], v[120:123]
    ds_read_b128 v[104:107], v5 offset:14336
    ds_read_b128 v[108:111], v5 offset:15360
    s_waitcnt lgkmcnt(6)
    v_mfma_f32_16x16x32_bf16 v[116:119], v[24:27], v[80:83], v[116:119]
    v_mfma_f32_16x16x32_bf16 v[120:123], v[24:27], v[84:87], v[120:123]
    ds_read_b128 v[80:83], v5 offset:16384
    ds_read_b128 v[84:87], v5 offset:17408
    s_waitcnt lgkmcnt(6)
    v_mfma_f32_16x16x32_bf16 v[116:119], v[28:31], v[88:91], v[116:119]
    v_mfma_f32_16x16x32_bf16 v[120:123], v[28:31], v[92:95], v[120:123]
    ds_read_b128 v[88:91], v5 offset:18432
    ds_read_b128 v[92:95], v5 offset:19456
    s_waitcnt lgkmcnt(6)
    v_mfma_f32_16x16x32_bf16 v[116:119], v[32:35], v[96:99], v[116:119]
    v_mfma_f32_16x16x32_bf16 v[120:123], v[32:35], v[100:103], v[120:123]
    ds_read_b128 v[96:99], v5 offset:20480
    ds_read_b128 v[100:103], v5 offset:21504
    s_waitcnt lgkmcnt(6)
    v_mfma_f32_16x16x32_bf16 v[116:119], v[36:39], v[104:107], v[116:119]
    v_mfma_f32_16x16x32_bf16 v[120:123], v[36:39], v[108:111], v[120:123]
    ds_read_b128 v[104:107], v5 offset:22528
    ds_read_b128 v[108:111], v5 offset:23552
    s_waitcnt lgkmcnt(6)
    v_mfma_f32_16x16x32_bf16 v[116:119], v[40:43], v[80:83], v[116:119]
    v_mfma_f32_16x16x32_bf16 v[120:123], v[40:43], v[84:87], v[120:123]
    ds_read_b128 v[80:83], v5 offset:24576
    ds_read_b128 v[84:87], v5 offset:25600
    s_waitcnt lgkmcnt(6)
    v_mfma_f32_16x16x32_bf16 v[116:119], v[44:47], v[88:91], v[116:119]
    v_mfma_f32_16x16x32_bf16 v[120:123], v[44:47], v[92:95], v[120:123]
    ds_read_b128 v[88:91], v5 offset:26624
    ds_read_b128 v[92:95], v5 offset:27648
    s_waitcnt lgkmcnt(6)
    v_mfma_f32_16x16x32_bf16 v[116:119], v[48:51], v[96:99], v[116:119]
    v_mfma_f32_16x16x32_bf16 v[120:123], v[48:51], v[100:103], v[120:123]
    ds_read_b128 v[96:99], v5 offset:28672
    ds_read_b128 v[100:103], v5 offset:29696
    s_waitcnt lgkmcnt(6)
    v_mfma_f32_16x16x32_bf16 v[116:119], v[52:55], v[104:107], v[116:119]
    v_mfma_f32_16x16x32_bf16 v[120:123], v[52:55], v[108:111], v[120:123]
    ds_read_b128 v[104:107], v5 offset:30720
    ds_read_b128 v[108:111], v5 offset:31744
    s_waitcnt lgkmcnt(6)
    v_mfma_f32_16x16x32_bf16 v[116:119], v[56:59], v[80:83], v[116:119]
    v_mfma_f32_16x16x32_bf16 v[120:123], v[56:59], v[84:87], v[120:123]
    ds_read_b128 v[80:83], v5 offset:32768
    ds_read_b128 v[84:87], v5 offset:33792
    s_waitcnt lgkmcnt(6)
    v_mfma_f32_16x16x32_bf16 v[116:119], v[60:63], v[88:91], v[116:119]
    v_mfma_f32_16x16x32_bf16 v[120:123], v[60:63], v[92:95], v[120:123]
    ds_read_b128 v[88:91], v5 offset:34816
    ds_read_b128 v[92:95], v5 offset:35840
    s_waitcnt lgkmcnt(6)
    v_mfma_f32_16x16x32_bf16 v[116:119], v[64:67], v[96:99], v[116:119]
    v_mfma_f32_16x16x32_bf16 v[120:123], v[64:67], v[100:103], v[120:123]
    s_waitcnt lgkmcnt(4)
    v_mfma_f32_16x16x32_bf16 v[116:119], v[68:71], v[104:107], v[116:119]
    v_mfma_f32_16x16x32_bf16 v[120:123], v[68:71], v[108:111], v[120:123]
    s_waitcnt lgkmcnt(2)
    v_mfma_f32_16x16x32_bf16 v[116:119], v[72:75], v[80:83], v[116:119]
    v_mfma_f32_16x16x32_bf16 v[120:123], v[72:75], v[84:87], v[120:123]
    s_waitcnt lgkmcnt(0)
    v_mfma_f32_16x16x32_bf16 v[116:119], v[76:79], v[88:91], v[116:119]
    v_mfma_f32_16x16x32_bf16 v[120:123], v[76:79], v[92:95], v[120:123]
    s_branch L_ka_gx
L_ka_g0:
    v_add_u32 v5, 0, v1
    v_and_b32 v2, 1, v3
    v_lshlrev_b32 v2, 6, v2
    v_lshl_add_u32 v2, v4, 4, v2
    v_add_u32 v2, 36864, v2
    v_lshrrev_b32 v6, 2, v3
    v_lshl_add_u32 v6, v4, 3, v6
    v_mul_u32_u24 v6, 288, v6
    v_and_b32 v7, 3, v3
    v_lshl_add_u32 v6, v7, 3, v6
    s_lshl_b32 s9, s6, 5
    s_add_u32 s9, s9, 43008
    v_add_u32 v6, s9, v6
    v_add_u32 v7, 64512, v6
    ds_read_b64_tr_b16 v[8:9], v6 offset:0
    ds_read_b64_tr_b16 v[10:11], v6 offset:1152
    ds_read_b64_tr_b16 v[12:13], v6 offset:9216
    ds_read_b64_tr_b16 v[14:15], v6 offset:10368
    ds_read_b64_tr_b16 v[16:17], v6 offset:18432
    ds_read_b64_tr_b16 v[18:19], v6 offset:19584
    ds_read_b128 v[80:83], v5 offset:0
    ds_read_b128 v[84:87], v5 offset:1024
    ds_read_b128 v[88:91], v5 offset:2048
    ds_read_b128 v[92:95], v5 offset:3072
    ds_read_b128 v[96:99], v5 offset:4096
    ds_read_b128 v[100:103], v5 offset:5120
    ds_read_b64_tr_b16 v[20:21], v6 offset:27648
    ds_read_b64_tr_b16 v[22:23], v6 offset:28800
    ds_read_b64_tr_b16 v[24:25], v6 offset:36864
    ds_read_b64_tr_b16 v[26:27], v6 offset:38016
    ds_read_b128 v[104:107], v5 offset:6144
    ds_read_b128 v[108:111], v5 offset:7168
    s_waitcnt lgkmcnt(10)
    v_mfma_f32_16x16x32_bf16 v[116:119], v[8:11], v[80:83], 0
    v_mfma_f32_16x16x32_bf16 v[120:123], v[8:11], v[84:87], 0
    ds_read_b64_tr_b16 v[28:29], v6 offset:46080
    ds_read_b64_tr_b16 v[30:31], v6 offset:47232
    ds_read_b64_tr_b16 v[32:33], v6 offset:55296
    ds_read_b64_tr_b16 v[34:35], v6 offset:56448
    ds_read_b128 v[80:83], v5 offset:8192
    ds_read_b128 v[84:87], v5 offset:9216
    s_waitcnt lgkmcnt(14)
    v_mfma_f32_16x16x32_bf16 v[116:119], v[12:15], v[88:91], v[116:119]
    v_mfma_f32_16x16x32_bf16 v[120:123], v[12:15], v[92:95], v[120:123]
    ds_read_b64_tr_b16 v[36:37], v7 offset:0
    ds_read_b64_tr_b16 v[38:39], v7 offset:1152
    ds_read_b64_tr_b16 v[40:41], v7 offset:9216
    ds_read_b64_tr_b16 v[42:43], v7 offset:10368
    ds_read_b128 v[88:91], v5 offset:10240
    ds_read_b128 v[92:95], v5 offset:11264
    s_waitcnt lgkmcnt(15)
    v_mfma_f32_16x16x32_bf16 v[116:119], v[16:19], v[96:99], v[116:119]
    v_mfma_f32_16x16x32_bf16 v[120:123], v[16:19], v[100:103], v[120:123]
    ds_read_b64_tr_b16 v[44:45], v7 offset:18432
    ds_read_b64_tr_b16 v[46:47], v7 offset:19584
    ds_read_b64_tr_b16 v[48:49], v7 offset:27648
    ds_read_b64_tr_b16 v[50:51], v7 offset:28800
    ds_read_b128 v[96:99], v5 offset:12288
    ds_read_b128 v[100:103], v5 offset:13312
    s_waitcnt lgkmcnt(15)
    v_mfma_f32_16x16x32_bf16 v[116:119], v[20:23], v[104:107], v[116:119]
    v_mfma_f32_16x16x32_bf16 v[120:123], v[20:23], v[108:111], v[120:123]
    ds_read_b64_tr_b16 v[52:53], v7 offset:36864
    ds_read_b64_tr_b16 v[54:55], v7 offset:38016
    ds_read_b64_tr_b16 v[56:57], v7 offset:46080
    ds_read_b64_tr_b16 v[58:59], v7 offset:47232
    ds_read_b128 v[104:107], v5 offset:14336
    ds_read_b128 v[108:111], v5 offset:15360
    s_waitcnt lgkmcnt(15)
    v_mfma_f32_16x16x32_bf16 v[116:119], v[24:27], v[80:83], v[116:119]
    v_mfma_f32_16x16x32_bf16 v[120:123], v[24:27], v[84:87], v[120:123]
    ds_read_b128 v[80:83], v5 offset:16384
    ds_read_b128 v[84:87], v5 offset:17408
    s_waitcnt lgkmcnt(14)
    v_mfma_f32_16x16x32_bf16 v[116:119], v[28:31], v[88:91], v[116:119]
    v_mfma_f32_16x16x32_bf16 v[120:123], v[28:31], v[92:95], v[120:123]
    ds_read_b128 v[88:91], v5 offset:18432
    ds_read_b128 v[92:95], v5 offset:19456
    s_waitcnt lgkmcnt(10)
    v_mfma_f32_16x16x32_bf16 v[116:119], v[32:35], v[96:99], v[116:119]
    v_mfma_f32_16x16x32_bf16 v[120:123], v[32:35], v[100:103], v[120:123]
    ds_read_b128 v[96:99], v5 offset:20480
    ds_read_b128 v[100:103], v5 offset:21504
    s_waitcnt lgkmcnt(6)
    v_mfma_f32_16x16x32_bf16 v[116:119], v[36:39], v[104:107], v[116:119]
    v_mfma_f32_16x16x32_bf16 v[120:123], v[36:39], v[108:111], v[120:123]
    s_waitcnt lgkmcnt(0)
    s_barrier
    ds_read_b128 v[104:107], v5 offset:22528
    ds_read_b128 v[108:111], v5 offset:23552
    s_waitcnt lgkmcnt(6)
    v_mfma_f32_16x16x32_bf16 v[116:119], v[40:43], v[80:83], v[116:119]
    v_mfma_f32_16x16x32_bf16 v[120:123], v[40:43], v[84:87], v[120:123]
    ds_read_b128 v[80:83], v5 offset:24576
    ds_read_b128 v[84:87], v5 offset:25600
    s_waitcnt lgkmcnt(6)
    v_mfma_f32_16x16x32_bf16 v[116:119], v[44:47], v[88:91], v[116:119]
    v_mfma_f32_16x16x32_bf16 v[120:123], v[44:47], v[92:95], v[120:123]
    ds_read_b128 v[88:91], v5 offset:26624
    ds_read_b128 v[92:95], v5 offset:27648
    s_waitcnt lgkmcnt(6)
    v_mfma_f32_16x16x32_bf16 v[116:119], v[48:51], v[96:99], v[116:119]
    v_mfma_f32_16x16x32_bf16 v[120:123], v[48:51], v[100:103], v[120:123]
    ds_read_b128 v[96:99], v5 offset:28672
    ds_read_b128 v[100:103], v5 offset:29696
    s_waitcnt lgkmcnt(6)
    v_mfma_f32_16x16x32_bf16 v[116:119], v[52:55], v[104:107], v[116:119]
    v_mfma_f32_16x16x32_bf16 v[120:123], v[52:55], v[108:111], v[120:123]
    s_barrier
    ds_read_b64_tr_b16 v[60:61], v6 offset:0
    ds_read_b64_tr_b16 v[62:63], v6 offset:1152
    ds_read_b64_tr_b16 v[64:65], v6 offset:9216
    ds_read_b64_tr_b16 v[66:67], v6 offset:10368
    ds_read_b64_tr_b16 v[68:69], v6 offset:18432
    ds_read_b64_tr_b16 v[70:71], v6 offset:19584
    ds_read_b64_tr_b16 v[72:73], v6 offset:27648
    ds_read_b64_tr_b16 v[74:75], v6 offset:28800
    ds_read_b64_tr_b16 v[76:77], v6 offset:36864
    ds_read_b64_tr_b16 v[78:79], v6 offset:38016
    ds_read_b128 v[104:107], v5 offset:30720
    ds_read_b128 v[108:111], v5 offset:31744
    s_waitcnt lgkmcnt(15)
    v_mfma_f32_16x16x32_bf16 v[116:119], v[56:59], v[80:83], v[116:119]
    v_mfma_f32_16x16x32_bf16 v[120:123], v[56:59], v[84:87], v[120:123]
    ds_read_b128 v[80:83], v5 offset:32768
    ds_read_b128 v[84:87], v5 offset:33792
    s_waitcnt lgkmcnt(2)
    v_mfma_f32_16x16x32_bf16 v[116:119], v[60:63], v[88:91], v[116:119]
    v_mfma_f32_16x16x32_bf16 v[120:123], v[60:63], v[92:95], v[120:123]
    ds_read_b128 v[88:91], v5 offset:34816
    ds_read_b128 v[92:95], v5 offset:35840
    s_waitcnt lgkmcnt(15)
    v_mfma_f32_16x16x32_bf16 v[116:119], v[64:67], v[96:99], v[116:119]
    v_mfma_f32_16x16x32_bf16 v[120:123], v[64:67], v[100:103], v[120:123]
    s_waitcnt lgkmcnt(4)
    v_mfma_f32_16x16x32_bf16 v[116:119], v[68:71], v[104:107], v[116:119]
    v_mfma_f32_16x16x32_bf16 v[120:123], v[68:71], v[108:111], v[120:123]
    s_waitcnt lgkmcnt(2)
    v_mfma_f32_16x16x32_bf16 v[116:119], v[72:75], v[80:83], v[116:119]
    v_mfma_f32_16x16x32_bf16 v[120:123], v[72:75], v[84:87], v[120:123]
    s_waitcnt lgkmcnt(0)
    v_mfma_f32_16x16x32_bf16 v[116:119], v[76:79], v[88:91], v[116:119]
    v_mfma_f32_16x16x32_bf16 v[120:123], v[76:79], v[92:95], v[120:123]
L_ka_gx:
    v_lshrrev_b32 v2, 4, v1
    v_lshlrev_b32 v7, 3, v3
    v_add_u32 v7, 42560, v7
    s_nop 7
    s_cmp_eq_u32 s6, 13
    s_cbranch_scc1 L_ka_kv
    s_mov_b32 s9, 0x3eae1a93
    v_mul_u32_u24 v6, 296, v3
    v_lshl_add_u32 v6, v4, 3, v6
    s_lshl_b32 s11, s6, 5
    s_add_u32 s11, s11, 89152
    v_add_u32 v6, s11, v6
    v_mul_f32 v116, s9, v116
    v_mul_f32 v117, s9, v117
    v_mul_f32 v118, s9, v118
    v_mul_f32 v119, s9, v119
    v_mul_f32 v120, s9, v120
    v_mul_f32 v121, s9, v121
    v_mul_f32 v122, s9, v122
    v_mul_f32 v123, s9, v123
    v_cvt_pk_bf16_f32 v8, v116, v117
    v_cvt_pk_bf16_f32 v9, v118, v119
    v_cvt_pk_bf16_f32 v10, v120, v121
    v_cvt_pk_bf16_f32 v11, v122, v123
    ds_write_b64 v6, v[8:9]
    ds_write_b64 v6, v[10:11] offset:4736
    s_branch L_ka_bq
L_ka_kv:
    s_mul_i32 s10, s20, 2368
    s_add_u32 s10, s10, 23068672
    v_mov_b32 v24, 0
    v_cvt_pk_bf16_f32 v8, v116, v117
    v_cvt_pk_bf16_f32 v9, v118, v119
    v_cvt_pk_bf16_f32 v10, v120, v121
    v_cvt_pk_bf16_f32 v11, v122, v123
    s_cmp_ge_u32 s21, 2
    s_cbranch_scc1 L_ka_v
    v_lshlrev_b32 v16, 16, v8
    v_and_b32 v17, 0xffff0000, v8
    v_lshlrev_b32 v18, 16, v9
    v_and_b32 v19, 0xffff0000, v9
    v_lshlrev_b32 v20, 16, v10
    v_and_b32 v21, 0xffff0000, v10
    v_lshlrev_b32 v22, 16, v11
    v_and_b32 v23, 0xffff0000, v11
    s_cmp_eq_u32 s21, 1
    s_cbranch_scc1 L_ka_k2
    v_lshrrev_b32 v6, 1, v4
    v_lshlrev_b32 v6, 9, v6
    v_lshl_add_u32 v6, v3, 4, v6
    v_and_b32 v7, 1, v4
    v_lshl_add_u32 v6, v7, 3, v6
    ds_write_b64 v6, v[8:9] offset:39168
    ds_write_b64 v6, v[10:11] offset:39424
    s_waitcnt lgkmcnt(0)
    ds_read_b128 v[28:31], v1 offset:39168
    s_waitcnt lgkmcnt(0)
    buffer_store_dwordx4 v[28:31], v1, s[12:15], s10 offen sc1
    v_mul_f32 v24, v16, v16
    v_mul_f32 v25, v20, v20
    v_fmac_f32 v24, v17, v17
    v_fmac_f32 v25, v21, v21
    v_fmac_f32 v24, v18, v18
    v_fmac_f32 v25, v22, v22
    v_fmac_f32 v24, v19, v19
    v_fmac_f32 v25, v23, v23
    v_mov_b32 v26, v24
    v_mov_b32 v27, v25
    s_nop 1
    v_permlane16_swap_b32 v24, v26
    v_permlane16_swap_b32 v25, v27
    s_nop 1
    v_add_f32 v24, v24, v26
    v_add_f32 v25, v25, v27
    v_mov_b32 v26, v24
    v_mov_b32 v27, v25
    s_nop 1
    v_permlane32_swap_b32 v24, v26
    v_permlane32_swap_b32 v25, v27
    s_nop 1
    v_add_f32 v24, v24, v26
    v_add_f32 v25, v25, v27
    s_branch L_ka_norm
L_ka_k2:
    v_lshlrev_b32 v6, 2, v3
    v_mul_f32 v24, v16, v16
    v_mul_f32 v25, v20, v20
    v_fmac_f32 v24, v17, v17
    v_fmac_f32 v25, v21, v21
    s_mov_b64 exec, 0xffff
    buffer_store_dword v8, v6, s[12:15], s10 offen offset:1024 sc1
    buffer_store_dword v10, v6, s[12:15], s10 offen offset:1088 sc1
    s_mov_b64 exec, -1
L_ka_norm:
    v_max_f32 v24, v24, v25
    s_nop 1
    v_max_f32_dpp v24, v24, v24 row_ror:1 row_mask:0xf bank_mask:0xf
    s_nop 1
    v_max_f32_dpp v24, v24, v24 row_ror:2 row_mask:0xf bank_mask:0xf
    s_nop 1
    v_max_f32_dpp v24, v24, v24 row_ror:4 row_mask:0xf bank_mask:0xf
    s_nop 1
    v_max_f32_dpp v24, v24, v24 row_ror:8 row_mask:0xf bank_mask:0xf
    s_branch L_ka_pub
L_ka_v:
    v_lshrrev_b32 v6, 2, v3
    v_and_b32 v6, 1, v6
    v_mul_u32_u24 v6, 304, v6
    v_lshrrev_b32 v7, 3, v3
    v_lshl_add_u32 v6, v7, 3, v6
    v_and_b32 v7, 3, v3
    v_lshl_add_u32 v6, v7, 1, v6
    v_lshl_add_u32 v6, v4, 6, v6
    s_add_u32 s10, s10, 1152
    s_cmp_eq_u32 s21, 3
    s_cbranch_scc1 L_ka_v2
    ds_write_b16 v6, v8 offset:39168
    ds_write_b16_d16_hi v6, v8 offset:39184
    ds_write_b16 v6, v9 offset:39200
    ds_write_b16_d16_hi v6, v9 offset:39216
    ds_write_b16 v6, v10 offset:39776
    ds_write_b16_d16_hi v6, v10 offset:39792
    ds_write_b16 v6, v11 offset:39808
    ds_write_b16_d16_hi v6, v11 offset:39824
    v_mul_u32_u24 v7, 304, v4
    v_lshl_add_u32 v7, v3, 4, v7
    s_waitcnt lgkmcnt(0)
    ds_read_b128 v[28:31], v7 offset:39168
    s_waitcnt lgkmcnt(0)
    buffer_store_dwordx4 v[28:31], v7, s[12:15], s10 offen sc1
    s_branch L_ka_pub
L_ka_v2:
    v_mov_b32 v9, 0x3f80
    s_mov_b64 exec, 0xffff
    ds_write_b16 v6, v8 offset:39424
    ds_write_b16_d16_hi v6, v8 offset:39440
    ds_write_b16 v6, v9 offset:39456
    ds_write_b16 v6, v10 offset:40032
    ds_write_b16_d16_hi v6, v10 offset:40048
    ds_write_b16 v6, v9 offset:40064
    s_mov_b64 exec, -1
    v_mul_u32_u24 v7, 304, v4
    v_lshl_add_u32 v7, v3, 4, v7
    v_cmp_gt_u32 vcc, 3, v3
    s_waitcnt lgkmcnt(0)
    s_and_saveexec_b64 s[48:49], vcc
    ds_read_b128 v[28:31], v7 offset:39424
    s_waitcnt lgkmcnt(0)
    buffer_store_dwordx4 v[28:31], v7, s[12:15], s10 offen offset:256 sc1
L_ka_pub:
    s_barrier
    s_mov_b64 exec, 1
    v_mov_b32 v25, v24
    v_mov_b32 v24, s3
    v_mov_b32 v6, 0
    s_lshl_b32 s11, s20, 7
    s_lshl_b32 s9, s21, 3
    s_add_u32 s11, s11, s9
    s_add_u32 s11, s11, 270336
    s_waitcnt vmcnt(0)
    buffer_store_dwordx2 v[24:25], v6, s[12:15], s11 offen sc1
    s_mov_b64 exec, -1
    s_setprio 0
    s_barrier
    s_barrier
    s_branch L_ka_bq2
L_ka_bq:
    s_waitcnt vmcnt(0) lgkmcnt(0)
    s_barrier
L_ka_bq2:
    s_load_dwordx4 s[24:27], s[0:1], 48
    s_load_dwordx2 s[28:29], s[0:1], 0
    s_load_dwordx2 s[30:31], s[0:1], 80
    s_mov_b32 s33, s34
    v_and_b32 v3, 31, v2
    v_lshrrev_b32 v4, 5, v2
    s_and_b32 s7, s6, 3
    s_lshr_b32 s8, s6, 2
    s_lshr_b32 s9, s63, 3
    s_and_b32 s23, s63, 3
    s_lshl_b32 s23, s23, 1
    s_and_b32 s10, s9, 1
    s_add_u32 s23, s23, s10
    s_lshr_b32 s55, s9, 1
    s_and_b32 s22, s63, 4
    s_xor_b32 s22, s22, 4
    s_lshl_b32 s22, s22, 2
    s_add_u32 s22, s22, s55
    s_cmp_ge_u32 s8, 1
    s_cbranch_scc1 L_kb_noq
    v_mul_u32_u24 v48, 296, v3
    s_mul_i32 s9, s7, 72
    s_add_u32 s9, s9, 89152
    v_add_u32 v48, s9, v48
    v_lshl_add_u32 v49, v4, 4, v48
    ds_read2_b32 v[8:9], v49 offset0:0 offset1:1
    ds_read2_b32 v[10:11], v49 offset0:2 offset1:3
    ds_read_b32 v12, v48 offset:32
    ds_read2_b32 v[14:15], v49 offset0:9 offset1:10
    ds_read2_b32 v[16:17], v49 offset0:11 offset1:12
    ds_read_b32 v18, v48 offset:68
    s_waitcnt lgkmcnt(0)
    v_cmp_eq_u32 vcc, 0, v4
    s_nop 1
    v_cndmask_b32 v12, 0, v12, vcc
    v_cndmask_b32 v18, 0, v18, vcc
    v_mov_b32 v56, 0
    v_lshlrev_b32 v54, 16, v8
    v_and_b32 v55, 0xffff0000, v8
    v_fmac_f32 v56, v54, v54
    v_fmac_f32 v56, v55, v55
    v_lshlrev_b32 v54, 16, v9
    v_and_b32 v55, 0xffff0000, v9
    v_fmac_f32 v56, v54, v54
    v_fmac_f32 v56, v55, v55
    v_lshlrev_b32 v54, 16, v10
    v_and_b32 v55, 0xffff0000, v10
    v_fmac_f32 v56, v54, v54
    v_fmac_f32 v56, v55, v55
    v_lshlrev_b32 v54, 16, v11
    v_and_b32 v55, 0xffff0000, v11
    v_fmac_f32 v56, v54, v54
    v_fmac_f32 v56, v55, v55
    v_lshlrev_b32 v54, 16, v12
    v_and_b32 v55, 0xffff0000, v12
    v_fmac_f32 v56, v54, v54
    v_fmac_f32 v56, v55, v55
    v_mov_b32 v57, 0
    v_lshlrev_b32 v54, 16, v14
    v_and_b32 v55, 0xffff0000, v14
    v_fmac_f32 v57, v54, v54
    v_fmac_f32 v57, v55, v55
    v_lshlrev_b32 v54, 16, v15
    v_and_b32 v55, 0xffff0000, v15
    v_fmac_f32 v57, v54, v54
    v_fmac_f32 v57, v55, v55
    v_lshlrev_b32 v54, 16, v16
    v_and_b32 v55, 0xffff0000, v16
    v_fmac_f32 v57, v54, v54
    v_fmac_f32 v57, v55, v55
    v_lshlrev_b32 v54, 16, v17
    v_and_b32 v55, 0xffff0000, v17
    v_fmac_f32 v57, v54, v54
    v_fmac_f32 v57, v55, v55
    v_lshlrev_b32 v54, 16, v18
    v_and_b32 v55, 0xffff0000, v18
    v_fmac_f32 v57, v54, v54
    v_fmac_f32 v57, v55, v55
    v_mov_b32 v54, v56
    v_mov_b32 v55, v57
    s_nop 1
    v_permlane32_swap_b32 v56, v54
    v_permlane32_swap_b32 v57, v55
    s_nop 1
    v_add_f32 v56, v56, v54
    v_add_f32 v57, v57, v55
L_kb_noq:
    s_waitcnt lgkmcnt(0)
    s_mul_i32 s11, s8, 37888
    v_add_u32 v5, s11, v1
    v_lshlrev_b32 v6, 2, v3
    s_add_u32 s9, s11, 1024
    v_add_u32 v6, s9, v6
    v_mov_b32 v7, 4
    v_subrev_u32 v54, 20, v3
    v_cmp_gt_u32 vcc, 8, v54
    s_nop 1
    v_cndmask_b32 v7, v7, 0, vcc
    v_cmp_gt_u32 vcc, 19, v3
    s_nop 1
    v_cndmask_b32 v7, v7, v3, vcc
    v_lshlrev_b32 v7, 4, v7
    v_mul_u32_u24 v54, 304, v4
    s_add_u32 s9, s11, 1152
    v_add3_u32 v7, v7, v54, s9
    v_mov_b32 v25, 0x3f803f80
    v_mov_b32 v31, 0x3f803f80
    s_mul_i32 s9, s7, 3072
    s_add_u32 s9, s9, 151552
    v_add_u32 v95, s9, v1
    s_mov_b32 s16, s24
    s_mov_b32 s17, s25
    s_mov_b32 s18, 5308416
    s_mov_b32 s19, 0x20000
    s_mov_b32 s56, s26
    s_mov_b32 s57, s27
    s_mov_b32 s58, 5308416
    s_mov_b32 s59, 0x20000
    v_mov_b32 v96, 0
    v_mov_b32 v97, 0
    v_mov_b32 v98, 0
    v_mov_b32 v99, 0
    s_cmp_lg_u32 s6, 4
    s_cbranch_scc1 L_kb_nopoll
    v_lshlrev_b32 v64, 7, v2
    v_lshlrev_b32 v65, 3, v2
    s_mov_b32 s10, 270336
    s_mov_b32 s11, 262144
L_kb_kvp:
    buffer_load_dwordx4 v[68:71], v64, s[12:15], s10 offen sc1
    buffer_load_dwordx4 v[72:75], v64, s[12:15], s10 offen offset:16 sc1
    s_waitcnt vmcnt(0)
    v_xor_b32 v68, s3, v68
    v_xor_b32 v70, s3, v70
    v_xor_b32 v72, s3, v72
    v_xor_b32 v74, s3, v74
    v_or3_b32 v68, v68, v70, v72
    v_or_b32 v68, v68, v74
    v_cmp_ne_u32 vcc, 0, v68
    s_cbranch_vccz L_kb_kvk
    s_sub_u32 s11, s11, 1
    s_cmp_lg_u32 s11, 0
    s_cbranch_scc1 L_kb_kvp
L_kb_kvk:
    v_mov_b32 v70, v69
    v_add_u32 v65, 98688, v65
    ds_write_b64 v65, v[70:71]
    s_waitcnt lgkmcnt(0)
L_kb_nopoll:
    s_barrier
    s_cmp_lt_u32 s6, 4
    s_cbranch_scc1 L_kb_nodma0
    s_cmp_eq_u32 s6, 9
    s_cbranch_scc1 L_kb_nodma0
    s_sub_u32 s50, s6, 4
    s_min_u32 s50, s50, 9
    s_cmp_eq_u32 s6, 14
    s_cselect_b32 s50, 5, s50
    s_lshl_b32 s50, s50, 10
    s_add_u32 s11, s50, 0
    s_mov_b32 m0, s11
    s_add_u32 s9, s11, 23068672
    buffer_load_dwordx4 v1, s[12:15], s9 offen sc1 lds
    s_add_u32 s11, s50, 37888
    s_mov_b32 m0, s11
    s_add_u32 s9, s11, 23068672
    buffer_load_dwordx4 v1, s[12:15], s9 offen sc1 lds
    s_add_u32 s11, s50, 75776
    s_mov_b32 m0, s11
    s_add_u32 s9, s11, 23068672
    buffer_load_dwordx4 v1, s[12:15], s9 offen sc1 lds
    s_add_u32 s11, s50, 113664
    s_mov_b32 m0, s11
    s_add_u32 s9, s11, 23068672
    buffer_load_dwordx4 v1, s[12:15], s9 offen sc1 lds
L_kb_nodma0:
    s_cmp_ge_u32 s8, 1
    s_cbranch_scc1 L_kb_qdone
    v_lshlrev_b32 v54, 3, v2
    v_add_u32 v54, 98688, v54
    ds_read_b64 v[52:53], v54
    s_waitcnt lgkmcnt(0)
    v_max_f32_dpp v52, v52, v52 row_ror:1 row_mask:0xf bank_mask:0xf
    v_max_f32_dpp v53, v53, v53 row_ror:1 row_mask:0xf bank_mask:0xf
    s_nop 0
    v_max_f32_dpp v52, v52, v52 row_ror:2 row_mask:0xf bank_mask:0xf
    v_max_f32_dpp v53, v53, v53 row_ror:2 row_mask:0xf bank_mask:0xf
    s_nop 0
    v_max_f32_dpp v52, v52, v52 row_ror:4 row_mask:0xf bank_mask:0xf
    v_max_f32_dpp v53, v53, v53 row_ror:4 row_mask:0xf bank_mask:0xf
    s_nop 0
    v_max_f32_dpp v52, v52, v52 row_ror:8 row_mask:0xf bank_mask:0xf
    v_max_f32_dpp v53, v53, v53 row_ror:8 row_mask:0xf bank_mask:0xf
    s_nop 0
    v_mov_b32 v54, v52
    v_mov_b32 v55, v53
    s_nop 1
    v_permlane16_swap_b32 v52, v54
    v_permlane16_swap_b32 v53, v55
    s_nop 1
    v_max_f32 v52, v52, v54
    v_max_f32 v53, v53, v55
    v_mov_b32 v54, v52
    v_mov_b32 v55, v53
    s_nop 1
    v_permlane32_swap_b32 v52, v54
    v_permlane32_swap_b32 v53, v55
    s_nop 1
    v_max_f32 v52, v52, v54
    v_max_f32 v53, v53, v55
    v_add_f32 v52, v52, v53
    v_mul_f32 v56, v56, v52
    v_mul_f32 v57, v57, v52
    v_sqrt_f32 v80, v56
    v_sqrt_f32 v81, v57
    s_nop 0
    v_max_f32 v54, v80, v81
    v_mov_b32 v55, 0x42700000
    v_cmp_nle_f32 vcc, v54, v55
    s_cbranch_vccnz L_kb_fallback
L_kb_shift:
    v_sub_f32 v80, 0, v80
    v_cvt_pk_bf16_f32 v82, v80, v80
    v_lshlrev_b32 v82, 16, v82
    v_sub_f32 v80, v80, v82
    v_cvt_pk_bf16_f32 v83, v80, v80
    v_lshlrev_b32 v83, 16, v83
    v_sub_f32 v80, v80, v83
    v_cvt_pk_bf16_f32 v82, v82, v83
    v_cvt_pk_bf16_f32 v83, v80, 0
    v_cmp_eq_u32 vcc, 0, v4
    s_nop 1
    v_cndmask_b32 v13, v83, v82, vcc
    v_sub_f32 v81, 0, v81
    v_cvt_pk_bf16_f32 v82, v81, v81
    v_lshlrev_b32 v82, 16, v82
    v_sub_f32 v81, v81, v82
    v_cvt_pk_bf16_f32 v83, v81, v81
    v_lshlrev_b32 v83, 16, v83
    v_sub_f32 v81, v81, v83
    v_cvt_pk_bf16_f32 v82, v82, v83
    v_cvt_pk_bf16_f32 v83, v81, 0
    v_cmp_eq_u32 vcc, 0, v4
    s_nop 1
    v_cndmask_b32 v19, v83, v82, vcc
    ds_write_b128 v95, v[8:11]
    ds_write_b128 v95, v[12:15] offset:1024
    ds_write_b128 v95, v[16:19] offset:2048
L_kb_qdone:
    s_cmp_eq_u32 s6, 9
    s_cbranch_scc1 L_kb_b0
    s_waitcnt vmcnt(0)
L_kb_b0:
    s_waitcnt lgkmcnt(0)
    s_barrier
    ds_read_b128 v[20:23], v5 offset:0
    ds_read_b32 v24, v6 offset:0
    ds_read_b128 v[32:35], v7 offset:0
    ds_read_b128 v[36:39], v7 offset:608
    ds_read_b128 v[8:11], v95
    ds_read_b128 v[12:15], v95 offset:1024
    ds_read_b128 v[16:19], v95 offset:2048
    s_mul_i32 s47, s8, 37888
    s_mul_i32 s9, s7, 9472
    s_add_u32 s47, s47, s9
    s_cmp_lt_u32 s6, 8
    s_cbranch_scc1 L_kb_go
    s_add_u32 s11, s6, 2
    s_lshl_b32 s11, s11, 10
    s_add_u32 s11, s11, 0
    s_mov_b32 m0, s11
    s_add_u32 s9, s11, 23068672
    buffer_load_dwordx4 v1, s[12:15], s9 offen sc1 lds
    s_add_u32 s11, s6, 10
    s_lshl_b32 s11, s11, 10
    s_add_u32 s11, s11, 0
    s_mov_b32 m0, s11
    s_add_u32 s9, s11, 23068672
    buffer_load_dwordx4 v1, s[12:15], s9 offen sc1 lds
    s_add_u32 s11, s6, 18
    s_lshl_b32 s11, s11, 10
    s_add_u32 s11, s11, 0
    s_mov_b32 m0, s11
    s_add_u32 s9, s11, 23068672
    buffer_load_dwordx4 v1, s[12:15], s9 offen sc1 lds
    s_add_u32 s11, s6, 26
    s_min_u32 s11, s11, 36
    s_lshl_b32 s11, s11, 10
    s_add_u32 s11, s11, 0
    s_mov_b32 m0, s11
    s_add_u32 s9, s11, 23068672
    buffer_load_dwordx4 v1, s[12:15], s9 offen sc1 lds
    s_add_u32 s11, s6, 2
    s_lshl_b32 s11, s11, 10
    s_add_u32 s11, s11, 37888
    s_mov_b32 m0, s11
    s_add_u32 s9, s11, 23068672
    buffer_load_dwordx4 v1, s[12:15], s9 offen sc1 lds
    s_add_u32 s11, s6, 10
    s_lshl_b32 s11, s11, 10
    s_add_u32 s11, s11, 37888
    s_mov_b32 m0, s11
    s_add_u32 s9, s11, 23068672
    buffer_load_dwordx4 v1, s[12:15], s9 offen sc1 lds
    s_add_u32 s11, s6, 18
    s_lshl_b32 s11, s11, 10
    s_add_u32 s11, s11, 37888
    s_mov_b32 m0, s11
    s_add_u32 s9, s11, 23068672
    buffer_load_dwordx4 v1, s[12:15], s9 offen sc1 lds
    s_add_u32 s11, s6, 26
    s_min_u32 s11, s11, 36
    s_lshl_b32 s11, s11, 10
    s_add_u32 s11, s11, 37888
    s_mov_b32 m0, s11
    s_add_u32 s9, s11, 23068672
    buffer_load_dwordx4 v1, s[12:15], s9 offen sc1 lds
    s_add_u32 s11, s6, 2
    s_lshl_b32 s11, s11, 10
    s_add_u32 s11, s11, 75776
    s_mov_b32 m0, s11
    s_add_u32 s9, s11, 23068672
    buffer_load_dwordx4 v1, s[12:15], s9 offen sc1 lds
    s_add_u32 s11, s6, 10
    s_lshl_b32 s11, s11, 10
    s_add_u32 s11, s11, 75776
    s_mov_b32 m0, s11
    s_add_u32 s9, s11, 23068672
    buffer_load_dwordx4 v1, s[12:15], s9 offen sc1 lds
    s_add_u32 s11, s6, 18
    s_lshl_b32 s11, s11, 10
    s_add_u32 s11, s11, 75776
    s_mov_b32 m0, s11
    s_add_u32 s9, s11, 23068672
    buffer_load_dwordx4 v1, s[12:15], s9 offen sc1 lds
    s_add_u32 s11, s6, 26
    s_min_u32 s11, s11, 36
    s_lshl_b32 s11, s11, 10
    s_add_u32 s11, s11, 75776
    s_mov_b32 m0, s11
    s_add_u32 s9, s11, 23068672
    buffer_load_dwordx4 v1, s[12:15], s9 offen sc1 lds
    s_add_u32 s11, s6, 2
    s_lshl_b32 s11, s11, 10
    s_add_u32 s11, s11, 113664
    s_mov_b32 m0, s11
    s_add_u32 s9, s11, 23068672
    buffer_load_dwordx4 v1, s[12:15], s9 offen sc1 lds
    s_add_u32 s11, s6, 10
    s_lshl_b32 s11, s11, 10
    s_add_u32 s11, s11, 113664
    s_mov_b32 m0, s11
    s_add_u32 s9, s11, 23068672
    buffer_load_dwordx4 v1, s[12:15], s9 offen sc1 lds
    s_add_u32 s11, s6, 18
    s_lshl_b32 s11, s11, 10
    s_add_u32 s11, s11, 113664
    s_mov_b32 m0, s11
    s_add_u32 s9, s11, 23068672
    buffer_load_dwordx4 v1, s[12:15], s9 offen sc1 lds
    s_add_u32 s11, s6, 26
    s_min_u32 s11, s11, 36
    s_lshl_b32 s11, s11, 10
    s_add_u32 s11, s11, 113664
    s_mov_b32 m0, s11
    s_add_u32 s9, s11, 23068672
    buffer_load_dwordx4 v1, s[12:15], s9 offen sc1 lds
L_kb_go:
    s_waitcnt lgkmcnt(0)
    s_cmp_lg_u32 s8, 0
    s_cbranch_scc1 L_kb_pr1
    s_setprio 3
L_kb_pr1:
    s_cmp_lg_u32 s8, 1
    s_cbranch_scc1 L_kb_pr2
    s_setprio 2
L_kb_pr2:
    s_cmp_lt_u32 s6, 12
    s_cbranch_scc1 L_kb_go2
    s_setprio 1
L_kb_go2:
    v_mfma_f32_32x32x8_bf16 v[48:63], v[24:25], v[12:13], 0
    v_mfma_f32_32x32x16_bf16 v[48:63], v[20:23], v[8:11], v[48:63]
    s_nop 7
    s_nop 3
    v_mfma_f32_32x32x8_bf16 v[64:79], v[24:25], v[18:19], 0
    v_exp_f32 v48, v48
    v_exp_f32 v49, v49
    v_exp_f32 v50, v50
    v_exp_f32 v51, v51
    v_mfma_f32_32x32x16_bf16 v[64:79], v[20:23], v[14:17], v[64:79]
    ds_read_b128 v[26:29], v5 offset:2368
    v_cvt_pk_bf16_f32 v80, v48, v49
    v_cvt_pk_bf16_f32 v81, v50, v51
    v_exp_f32 v52, v52
    v_exp_f32 v53, v53
    v_exp_f32 v54, v54
    v_exp_f32 v55, v55
    s_nop 0
    ds_read_b32 v30, v6 offset:2368
    v_cvt_pk_bf16_f32 v82, v52, v53
    v_cvt_pk_bf16_f32 v83, v54, v55
    v_exp_f32 v56, v56
    v_exp_f32 v57, v57
    v_exp_f32 v58, v58
    v_exp_f32 v59, v59
    s_nop 0
    v_cvt_pk_bf16_f32 v84, v56, v57
    v_cvt_pk_bf16_f32 v85, v58, v59
    v_exp_f32 v60, v60
    v_exp_f32 v61, v61
    v_exp_f32 v62, v62
    v_exp_f32 v63, v63
    v_cvt_pk_bf16_f32 v86, v60, v61
    v_cvt_pk_bf16_f32 v87, v62, v63
    s_waitcnt lgkmcnt(0)
    v_mfma_f32_32x32x8_bf16 v[48:63], v[30:31], v[12:13], 0
    v_exp_f32 v64, v64
    v_exp_f32 v65, v65
    v_exp_f32 v66, v66
    v_exp_f32 v67, v67
    v_mfma_f32_32x32x16_bf16 v[48:63], v[26:29], v[8:11], v[48:63]
    ds_read_b128 v[40:43], v7 offset:2368
    v_cvt_pk_bf16_f32 v88, v64, v65
    v_cvt_pk_bf16_f32 v89, v66, v67
    v_exp_f32 v68, v68
    v_exp_f32 v69, v69
    v_exp_f32 v70, v70
    v_exp_f32 v71, v71
    v_mfma_f32_32x32x16_bf16 v[96:111], v[32:35], v[80:83], 0
    ds_read_b128 v[44:47], v7 offset:2976
    v_cvt_pk_bf16_f32 v90, v68, v69
    v_cvt_pk_bf16_f32 v91, v70, v71
    v_exp_f32 v72, v72
    v_exp_f32 v73, v73
    v_exp_f32 v74, v74
    v_exp_f32 v75, v75
    v_mfma_f32_32x32x16_bf16 v[96:111], v[36:39], v[84:87], v[96:111]
    v_cvt_pk_bf16_f32 v92, v72, v73
    v_cvt_pk_bf16_f32 v93, v74, v75
    v_exp_f32 v76, v76
    v_exp_f32 v77, v77
    v_exp_f32 v78, v78
    v_exp_f32 v79, v79
    v_cvt_pk_bf16_f32 v94, v76, v77
    v_cvt_pk_bf16_f32 v95, v78, v79
    s_cmp_lg_u32 s8, 2
    s_cbranch_scc1 L_kb_nb2
    s_waitcnt vmcnt(0)
    s_barrier
L_kb_nb2:
    s_cmp_ge_u32 s8, 2
    s_cbranch_scc1 L_kb_nodec
    s_mul_i32 s36, s2, 21846
    s_lshr_b32 s36, s36, 16
    s_mul_i32 s37, s36, 3
    s_sub_u32 s37, s2, s37
    s_lshl_b32 s36, s36, 2
    s_add_u32 s36, s36, s7
    s_mul_i32 s38, s37, 6
    s_mul_i32 s44, s38, 294912
    s_lshl_b32 s45, s36, 5
    s_add_u32 s44, s44, s45
    s_mul_i32 s46, s36, 18
    s_add_u32 s46, s46, s38
    s_lshl_b32 s46, s46, 10
    s_add_u32 s46, s46, 4194304
    s_mul_i32 s50, s2, 7282
    s_lshr_b32 s50, s50, 16
    s_mul_i32 s51, s50, 9
    s_sub_u32 s51, s2, s51
    s_lshl_b32 s51, s51, 2
    s_add_u32 s51, s51, s7
    s_mul_i32 s52, s50, 21846
    s_lshr_b32 s52, s52, 16
    s_mul_i32 s53, s52, 3
    s_sub_u32 s53, s50, s53
    s_mul_i32 s53, s53, 6
    s_mul_i32 s49, s52, 36
    s_add_u32 s49, s49, s51
    s_mul_i32 s49, s49, 18
    s_add_u32 s49, s49, s53
    s_lshl_b32 s49, s49, 10
    s_add_u32 s49, s49, 10485760
    s_mul_i32 s48, s50, 221184
    s_lshl_b32 s45, s51, 5
    s_add_u32 s48, s48, s45
L_kb_nodec:
    v_mfma_f32_32x32x8_bf16 v[64:79], v[30:31], v[18:19], 0
    v_exp_f32 v48, v48
    v_exp_f32 v49, v49
    v_exp_f32 v50, v50
    v_exp_f32 v51, v51
    v_mfma_f32_32x32x16_bf16 v[64:79], v[26:29], v[14:17], v[64:79]
    ds_read_b128 v[20:23], v5 offset:4736
    v_cvt_pk_bf16_f32 v80, v48, v49
    v_cvt_pk_bf16_f32 v81, v50, v51
    v_exp_f32 v52, v52
    v_exp_f32 v53, v53
    v_exp_f32 v54, v54
    v_exp_f32 v55, v55
    v_mfma_f32_32x32x16_bf16 v[112:127], v[32:35], v[88:91], 0
    ds_read_b32 v24, v6 offset:4736
    v_cvt_pk_bf16_f32 v82, v52, v53
    v_cvt_pk_bf16_f32 v83, v54, v55
    v_exp_f32 v56, v56
    v_exp_f32 v57, v57
    v_exp_f32 v58, v58
    v_exp_f32 v59, v59
    v_mfma_f32_32x32x16_bf16 v[112:127], v[36:39], v[92:95], v[112:127]
    v_cvt_pk_bf16_f32 v84, v56, v57
    v_cvt_pk_bf16_f32 v85, v58, v59
    v_exp_f32 v60, v60
    v_exp_f32 v61, v61
    v_exp_f32 v62, v62
    v_exp_f32 v63, v63
    v_cvt_pk_bf16_f32 v86, v60, v61
    v_cvt_pk_bf16_f32 v87, v62, v63
    s_waitcnt lgkmcnt(0)
    v_mfma_f32_32x32x8_bf16 v[48:63], v[24:25], v[12:13], 0
    v_exp_f32 v64, v64
    v_exp_f32 v65, v65
    v_exp_f32 v66, v66
    v_exp_f32 v67, v67
    v_mfma_f32_32x32x16_bf16 v[48:63], v[20:23], v[8:11], v[48:63]
    ds_read_b128 v[32:35], v7 offset:4736
    v_cvt_pk_bf16_f32 v88, v64, v65
    v_cvt_pk_bf16_f32 v89, v66, v67
    v_exp_f32 v68, v68
    v_exp_f32 v69, v69
    v_exp_f32 v70, v70
    v_exp_f32 v71, v71
    v_mfma_f32_32x32x16_bf16 v[96:111], v[40:43], v[80:83], v[96:111]
    ds_read_b128 v[36:39], v7 offset:5344
    v_cvt_pk_bf16_f32 v90, v68, v69
    v_cvt_pk_bf16_f32 v91, v70, v71
    v_exp_f32 v72, v72
    v_exp_f32 v73, v73
    v_exp_f32 v74, v74
    v_exp_f32 v75, v75
    v_mfma_f32_32x32x16_bf16 v[96:111], v[44:47], v[84:87], v[96:111]
    v_cvt_pk_bf16_f32 v92, v72, v73
    v_cvt_pk_bf16_f32 v93, v74, v75
    v_exp_f32 v76, v76
    v_exp_f32 v77, v77
    v_exp_f32 v78, v78
    v_exp_f32 v79, v79
    v_cvt_pk_bf16_f32 v94, v76, v77
    v_cvt_pk_bf16_f32 v95, v78, v79
    s_cmp_lg_u32 s8, 3
    s_cbranch_scc1 L_kb_nb3
    s_waitcnt vmcnt(0)
    s_barrier
    s_cmp_lg_u32 s6, 15
    s_cbranch_scc1 L_kb_nf2b
    s_lshl_b32 s11, s20, 7
    s_lshl_b32 s9, s21, 2
    s_add_u32 s11, s11, s9
    s_add_u32 s11, s11, 376832
    v_mov_b32 v81, s3
    v_mov_b32 v82, 0
    s_mov_b64 exec, 1
    buffer_store_dword v81, v82, s[12:15], s11 offen sc1
    s_mov_b64 exec, -1
L_kb_nf2b:
L_kb_nb3:
    v_mfma_f32_32x32x8_bf16 v[64:79], v[24:25], v[18:19], 0
    v_exp_f32 v48, v48
    v_exp_f32 v49, v49
    v_exp_f32 v50, v50
    v_exp_f32 v51, v51
    v_mfma_f32_32x32x16_bf16 v[64:79], v[20:23], v[14:17], v[64:79]
    ds_read_b128 v[26:29], v5 offset:7104
    v_cvt_pk_bf16_f32 v80, v48, v49
    v_cvt_pk_bf16_f32 v81, v50, v51
    v_exp_f32 v52, v52
    v_exp_f32 v53, v53
    v_exp_f32 v54, v54
    v_exp_f32 v55, v55
    v_mfma_f32_32x32x16_bf16 v[112:127], v[40:43], v[88:91], v[112:127]
    ds_read_b32 v30, v6 offset:7104
    v_cvt_pk_bf16_f32 v82, v52, v53
    v_cvt_pk_bf16_f32 v83, v54, v55
    v_exp_f32 v56, v56
    v_exp_f32 v57, v57
    v_exp_f32 v58, v58
    v_exp_f32 v59, v59
    v_mfma_f32_32x32x16_bf16 v[112:127], v[44:47], v[92:95], v[112:127]
    v_cvt_pk_bf16_f32 v84, v56, v57
    v_cvt_pk_bf16_f32 v85, v58, v59
    v_exp_f32 v60, v60
    v_exp_f32 v61, v61
    v_exp_f32 v62, v62
    v_exp_f32 v63, v63
    v_cvt_pk_bf16_f32 v86, v60, v61
    v_cvt_pk_bf16_f32 v87, v62, v63
    s_waitcnt lgkmcnt(0)
    v_mfma_f32_32x32x8_bf16 v[48:63], v[30:31], v[12:13], 0
    v_exp_f32 v64, v64
    v_exp_f32 v65, v65
    v_exp_f32 v66, v66
    v_exp_f32 v67, v67
    v_mfma_f32_32x32x16_bf16 v[48:63], v[26:29], v[8:11], v[48:63]
    ds_read_b128 v[40:43], v7 offset:7104
    v_cvt_pk_bf16_f32 v88, v64, v65
    v_cvt_pk_bf16_f32 v89, v66, v67
    v_exp_f32 v68, v68
    v_exp_f32 v69, v69
    v_exp_f32 v70, v70
    v_exp_f32 v71, v71
    v_mfma_f32_32x32x16_bf16 v[96:111], v[32:35], v[80:83], v[96:111]
    ds_read_b128 v[44:47], v7 offset:7712
    v_cvt_pk_bf16_f32 v90, v68, v69
    v_cvt_pk_bf16_f32 v91, v70, v71
    v_exp_f32 v72, v72
    v_exp_f32 v73, v73
    v_exp_f32 v74, v74
    v_exp_f32 v75, v75
    v_mfma_f32_32x32x16_bf16 v[96:111], v[36:39], v[84:87], v[96:111]
    v_cvt_pk_bf16_f32 v92, v72, v73
    v_cvt_pk_bf16_f32 v93, v74, v75
    v_exp_f32 v76, v76
    v_exp_f32 v77, v77
    v_exp_f32 v78, v78
    v_exp_f32 v79, v79
    v_cvt_pk_bf16_f32 v94, v76, v77
    v_cvt_pk_bf16_f32 v95, v78, v79
    s_cmp_lg_u32 s8, 0
    s_cbranch_scc1 L_kb_nb0
    s_barrier
L_kb_nb0:
    s_cmp_lg_u32 s8, 1
    s_cbranch_scc1 L_kb_nb1
    s_barrier
L_kb_nb1:
    v_mfma_f32_32x32x8_bf16 v[64:79], v[30:31], v[18:19], 0
    v_exp_f32 v48, v48
    v_exp_f32 v49, v49
    v_exp_f32 v50, v50
    v_exp_f32 v51, v51
    v_mfma_f32_32x32x16_bf16 v[64:79], v[26:29], v[14:17], v[64:79]
    ds_read_b128 v[20:23], v5 offset:9472
    v_cvt_pk_bf16_f32 v80, v48, v49
    v_cvt_pk_bf16_f32 v81, v50, v51
    v_exp_f32 v52, v52
    v_exp_f32 v53, v53
    v_exp_f32 v54, v54
    v_exp_f32 v55, v55
    v_mfma_f32_32x32x16_bf16 v[112:127], v[32:35], v[88:91], v[112:127]
    ds_read_b32 v24, v6 offset:9472
    v_cvt_pk_bf16_f32 v82, v52, v53
    v_cvt_pk_bf16_f32 v83, v54, v55
    v_exp_f32 v56, v56
    v_exp_f32 v57, v57
    v_exp_f32 v58, v58
    v_exp_f32 v59, v59
    v_mfma_f32_32x32x16_bf16 v[112:127], v[36:39], v[92:95], v[112:127]
    v_cvt_pk_bf16_f32 v84, v56, v57
    v_cvt_pk_bf16_f32 v85, v58, v59
    v_exp_f32 v60, v60
    v_exp_f32 v61, v61
    v_exp_f32 v62, v62
    v_exp_f32 v63, v63
    v_cvt_pk_bf16_f32 v86, v60, v61
    v_cvt_pk_bf16_f32 v87, v62, v63
    s_waitcnt lgkmcnt(0)
    v_mfma_f32_32x32x8_bf16 v[48:63], v[24:25], v[12:13], 0
    v_exp_f32 v64, v64
    v_exp_f32 v65, v65
    v_exp_f32 v66, v66
    v_exp_f32 v67, v67
    v_mfma_f32_32x32x16_bf16 v[48:63], v[20:23], v[8:11], v[48:63]
    ds_read_b128 v[32:35], v7 offset:9472
    v_cvt_pk_bf16_f32 v88, v64, v65
    v_cvt_pk_bf16_f32 v89, v66, v67
    v_exp_f32 v68, v68
    v_exp_f32 v69, v69
    v_exp_f32 v70, v70
    v_exp_f32 v71, v71
    v_mfma_f32_32x32x16_bf16 v[96:111], v[40:43], v[80:83], v[96:111]
    ds_read_b128 v[36:39], v7 offset:10080
    v_cvt_pk_bf16_f32 v90, v68, v69
    v_cvt_pk_bf16_f32 v91, v70, v71
    v_exp_f32 v72, v72
    v_exp_f32 v73, v73
    v_exp_f32 v74, v74
    v_exp_f32 v75, v75
    v_mfma_f32_32x32x16_bf16 v[96:111], v[44:47], v[84:87], v[96:111]
    v_cvt_pk_bf16_f32 v92, v72, v73
    v_cvt_pk_bf16_f32 v93, v74, v75
    v_exp_f32 v76, v76
    v_exp_f32 v77, v77
    v_exp_f32 v78, v78
    v_exp_f32 v79, v79
    v_cvt_pk_bf16_f32 v94, v76, v77
    v_cvt_pk_bf16_f32 v95, v78, v79
    s_cmp_ge_u32 s6, 3
    s_cbranch_scc1 L_kb_notouch
    s_cmp_ge_u32 s2, 216
    s_cbranch_scc1 L_kb_notouch
    v_mul_u32_u24 v80, 9216, v2
    v_mul_u32_u24 v81, 1152, v2
    s_mul_i32 s9, s7, 589824
    s_add_u32 s9, s9, s44
    s_mul_i32 s10, s7, 73728
    s_add_u32 s10, s10, s48
    buffer_load_dword v0, v80, s[16:19], s9 offen
    buffer_load_dword v0, v81, s[56:59], s10 offen
    s_cmp_lg_u32 s6, 0
    s_cbranch_scc1 L_kb_notouch
    v_lshlrev_b32 v80, 7, v2
    s_lshl_b32 s9, s36, 9
    s_add_u32 s9, s9, 32768
    s_mov_b64 exec, 0xffff
    buffer_load_dword v0, v80, s[12:15], s9 offen sc1
    s_lshl_b32 s9, s20, 7
    s_add_u32 s10, s9, 344064
    s_add_u32 s9, s9, 278528
    s_mov_b64 exec, 1
    buffer_load_dword v0, v80, s[12:15], s9 offen sc1
    buffer_load_dword v0, v80, s[12:15], s10 offen sc1
    s_mov_b64 exec, -1
L_kb_notouch:
    v_mfma_f32_32x32x8_bf16 v[64:79], v[24:25], v[18:19], 0
    v_exp_f32 v48, v48
    v_exp_f32 v49, v49
    v_exp_f32 v50, v50
    v_exp_f32 v51, v51
    v_mfma_f32_32x32x16_bf16 v[64:79], v[20:23], v[14:17], v[64:79]
    ds_read_b128 v[26:29], v5 offset:11840
    v_cvt_pk_bf16_f32 v80, v48, v49
    v_cvt_pk_bf16_f32 v81, v50, v51
    v_exp_f32 v52, v52
    v_exp_f32 v53, v53
    v_exp_f32 v54, v54
    v_exp_f32 v55, v55
    v_mfma_f32_32x32x16_bf16 v[112:127], v[40:43], v[88:91], v[112:127]
    ds_read_b32 v30, v6 offset:11840
    v_cvt_pk_bf16_f32 v82, v52, v53
    v_cvt_pk_bf16_f32 v83, v54, v55
    v_exp_f32 v56, v56
    v_exp_f32 v57, v57
    v_exp_f32 v58, v58
    v_exp_f32 v59, v59
    v_mfma_f32_32x32x16_bf16 v[112:127], v[44:47], v[92:95], v[112:127]
    v_cvt_pk_bf16_f32 v84, v56, v57
    v_cvt_pk_bf16_f32 v85, v58, v59
    v_exp_f32 v60, v60
    v_exp_f32 v61, v61
    v_exp_f32 v62, v62
    v_exp_f32 v63, v63
    v_cvt_pk_bf16_f32 v86, v60, v61
    v_cvt_pk_bf16_f32 v87, v62, v63
    s_waitcnt lgkmcnt(0)
    v_mfma_f32_32x32x8_bf16 v[48:63], v[30:31], v[12:13], 0
    v_exp_f32 v64, v64
    v_exp_f32 v65, v65
    v_exp_f32 v66, v66
    v_exp_f32 v67, v67
    v_mfma_f32_32x32x16_bf16 v[48:63], v[26:29], v[8:11], v[48:63]
    ds_read_b128 v[40:43], v7 offset:11840
    v_cvt_pk_bf16_f32 v88, v64, v65
    v_cvt_pk_bf16_f32 v89, v66, v67
    v_exp_f32 v68, v68
    v_exp_f32 v69, v69
    v_exp_f32 v70, v70
    v_exp_f32 v71, v71
    v_mfma_f32_32x32x16_bf16 v[96:111], v[32:35], v[80:83], v[96:111]
    ds_read_b128 v[44:47], v7 offset:12448
    v_cvt_pk_bf16_f32 v90, v68, v69
    v_cvt_pk_bf16_f32 v91, v70, v71
    v_exp_f32 v72, v72
    v_exp_f32 v73, v73
    v_exp_f32 v74, v74
    v_exp_f32 v75, v75
    v_mfma_f32_32x32x16_bf16 v[96:111], v[36:39], v[84:87], v[96:111]
    v_cvt_pk_bf16_f32 v92, v72, v73
    v_cvt_pk_bf16_f32 v93, v74, v75
    v_exp_f32 v76, v76
    v_exp_f32 v77, v77
    v_exp_f32 v78, v78
    v_exp_f32 v79, v79
    v_cvt_pk_bf16_f32 v94, v76, v77
    v_cvt_pk_bf16_f32 v95, v78, v79
    v_mfma_f32_32x32x8_bf16 v[64:79], v[30:31], v[18:19], 0
    v_exp_f32 v48, v48
    v_exp_f32 v49, v49
    v_exp_f32 v50, v50
    v_exp_f32 v51, v51
    v_mfma_f32_32x32x16_bf16 v[64:79], v[26:29], v[14:17], v[64:79]
    ds_read_b128 v[20:23], v5 offset:14208
    v_cvt_pk_bf16_f32 v80, v48, v49
    v_cvt_pk_bf16_f32 v81, v50, v51
    v_exp_f32 v52, v52
    v_exp_f32 v53, v53
    v_exp_f32 v54, v54
    v_exp_f32 v55, v55
    v_mfma_f32_32x32x16_bf16 v[112:127], v[32:35], v[88:91], v[112:127]
    ds_read_b32 v24, v6 offset:14208
    v_cvt_pk_bf16_f32 v82, v52, v53
    v_cvt_pk_bf16_f32 v83, v54, v55
    v_exp_f32 v56, v56
    v_exp_f32 v57, v57
    v_exp_f32 v58, v58
    v_exp_f32 v59, v59
    v_mfma_f32_32x32x16_bf16 v[112:127], v[36:39], v[92:95], v[112:127]
    v_cvt_pk_bf16_f32 v84, v56, v57
    v_cvt_pk_bf16_f32 v85, v58, v59
    v_exp_f32 v60, v60
    v_exp_f32 v61, v61
    v_exp_f32 v62, v62
    v_exp_f32 v63, v63
    v_cvt_pk_bf16_f32 v86, v60, v61
    v_cvt_pk_bf16_f32 v87, v62, v63
    s_waitcnt lgkmcnt(0)
    v_mfma_f32_32x32x8_bf16 v[48:63], v[24:25], v[12:13], 0
    v_exp_f32 v64, v64
    v_exp_f32 v65, v65
    v_exp_f32 v66, v66
    v_exp_f32 v67, v67
    v_mfma_f32_32x32x16_bf16 v[48:63], v[20:23], v[8:11], v[48:63]
    ds_read_b128 v[32:35], v7 offset:14208
    v_cvt_pk_bf16_f32 v88, v64, v65
    v_cvt_pk_bf16_f32 v89, v66, v67
    v_exp_f32 v68, v68
    v_exp_f32 v69, v69
    v_exp_f32 v70, v70
    v_exp_f32 v71, v71
    v_mfma_f32_32x32x16_bf16 v[96:111], v[40:43], v[80:83], v[96:111]
    ds_read_b128 v[36:39], v7 offset:14816
    v_cvt_pk_bf16_f32 v90, v68, v69
    v_cvt_pk_bf16_f32 v91, v70, v71
    v_exp_f32 v72, v72
    v_exp_f32 v73, v73
    v_exp_f32 v74, v74
    v_exp_f32 v75, v75
    v_mfma_f32_32x32x16_bf16 v[96:111], v[44:47], v[84:87], v[96:111]
    v_cvt_pk_bf16_f32 v92, v72, v73
    v_cvt_pk_bf16_f32 v93, v74, v75
    v_exp_f32 v76, v76
    v_exp_f32 v77, v77
    v_exp_f32 v78, v78
    v_exp_f32 v79, v79
    v_cvt_pk_bf16_f32 v94, v76, v77
    v_cvt_pk_bf16_f32 v95, v78, v79
    v_mfma_f32_32x32x8_bf16 v[64:79], v[24:25], v[18:19], 0
    v_exp_f32 v48, v48
    v_exp_f32 v49, v49
    v_exp_f32 v50, v50
    v_exp_f32 v51, v51
    v_mfma_f32_32x32x16_bf16 v[64:79], v[20:23], v[14:17], v[64:79]
    ds_read_b128 v[26:29], v5 offset:16576
    v_cvt_pk_bf16_f32 v80, v48, v49
    v_cvt_pk_bf16_f32 v81, v50, v51
    v_exp_f32 v52, v52
    v_exp_f32 v53, v53
    v_exp_f32 v54, v54
    v_exp_f32 v55, v55
    v_mfma_f32_32x32x16_bf16 v[112:127], v[40:43], v[88:91], v[112:127]
    ds_read_b32 v30, v6 offset:16576
    v_cvt_pk_bf16_f32 v82, v52, v53
    v_cvt_pk_bf16_f32 v83, v54, v55
    v_exp_f32 v56, v56
    v_exp_f32 v57, v57
    v_exp_f32 v58, v58
    v_exp_f32 v59, v59
    v_mfma_f32_32x32x16_bf16 v[112:127], v[44:47], v[92:95], v[112:127]
    v_cvt_pk_bf16_f32 v84, v56, v57
    v_cvt_pk_bf16_f32 v85, v58, v59
    v_exp_f32 v60, v60
    v_exp_f32 v61, v61
    v_exp_f32 v62, v62
    v_exp_f32 v63, v63
    v_cvt_pk_bf16_f32 v86, v60, v61
    v_cvt_pk_bf16_f32 v87, v62, v63
    s_waitcnt lgkmcnt(0)
    v_mfma_f32_32x32x8_bf16 v[48:63], v[30:31], v[12:13], 0
    v_exp_f32 v64, v64
    v_exp_f32 v65, v65
    v_exp_f32 v66, v66
    v_exp_f32 v67, v67
    v_mfma_f32_32x32x16_bf16 v[48:63], v[26:29], v[8:11], v[48:63]
    ds_read_b128 v[40:43], v7 offset:16576
    v_cvt_pk_bf16_f32 v88, v64, v65
    v_cvt_pk_bf16_f32 v89, v66, v67
    v_exp_f32 v68, v68
    v_exp_f32 v69, v69
    v_exp_f32 v70, v70
    v_exp_f32 v71, v71
    v_mfma_f32_32x32x16_bf16 v[96:111], v[32:35], v[80:83], v[96:111]
    ds_read_b128 v[44:47], v7 offset:17184
    v_cvt_pk_bf16_f32 v90, v68, v69
    v_cvt_pk_bf16_f32 v91, v70, v71
    v_exp_f32 v72, v72
    v_exp_f32 v73, v73
    v_exp_f32 v74, v74
    v_exp_f32 v75, v75
    v_mfma_f32_32x32x16_bf16 v[96:111], v[36:39], v[84:87], v[96:111]
    v_cvt_pk_bf16_f32 v92, v72, v73
    v_cvt_pk_bf16_f32 v93, v74, v75
    v_exp_f32 v76, v76
    v_exp_f32 v77, v77
    v_exp_f32 v78, v78
    v_exp_f32 v79, v79
    v_cvt_pk_bf16_f32 v94, v76, v77
    v_cvt_pk_bf16_f32 v95, v78, v79
    v_mfma_f32_32x32x8_bf16 v[64:79], v[30:31], v[18:19], 0
    v_exp_f32 v48, v48
    v_exp_f32 v49, v49
    v_exp_f32 v50, v50
    v_exp_f32 v51, v51
    v_mfma_f32_32x32x16_bf16 v[64:79], v[26:29], v[14:17], v[64:79]
    ds_read_b128 v[20:23], v5 offset:18944
    v_cvt_pk_bf16_f32 v80, v48, v49
    v_cvt_pk_bf16_f32 v81, v50, v51
    v_exp_f32 v52, v52
    v_exp_f32 v53, v53
    v_exp_f32 v54, v54
    v_exp_f32 v55, v55
    v_mfma_f32_32x32x16_bf16 v[112:127], v[32:35], v[88:91], v[112:127]
    ds_read_b32 v24, v6 offset:18944
    v_cvt_pk_bf16_f32 v82, v52, v53
    v_cvt_pk_bf16_f32 v83, v54, v55
    v_exp_f32 v56, v56
    v_exp_f32 v57, v57
    v_exp_f32 v58, v58
    v_exp_f32 v59, v59
    v_mfma_f32_32x32x16_bf16 v[112:127], v[36:39], v[92:95], v[112:127]
    v_cvt_pk_bf16_f32 v84, v56, v57
    v_cvt_pk_bf16_f32 v85, v58, v59
    v_exp_f32 v60, v60
    v_exp_f32 v61, v61
    v_exp_f32 v62, v62
    v_exp_f32 v63, v63
    v_cvt_pk_bf16_f32 v86, v60, v61
    v_cvt_pk_bf16_f32 v87, v62, v63
    s_waitcnt lgkmcnt(0)
    v_mfma_f32_32x32x8_bf16 v[48:63], v[24:25], v[12:13], 0
    v_exp_f32 v64, v64
    v_exp_f32 v65, v65
    v_exp_f32 v66, v66
    v_exp_f32 v67, v67
    v_mfma_f32_32x32x16_bf16 v[48:63], v[20:23], v[8:11], v[48:63]
    ds_read_b128 v[32:35], v7 offset:18944
    v_cvt_pk_bf16_f32 v88, v64, v65
    v_cvt_pk_bf16_f32 v89, v66, v67
    v_exp_f32 v68, v68
    v_exp_f32 v69, v69
    v_exp_f32 v70, v70
    v_exp_f32 v71, v71
    v_mfma_f32_32x32x16_bf16 v[96:111], v[40:43], v[80:83], v[96:111]
    ds_read_b128 v[36:39], v7 offset:19552
    v_cvt_pk_bf16_f32 v90, v68, v69
    v_cvt_pk_bf16_f32 v91, v70, v71
    v_exp_f32 v72, v72
    v_exp_f32 v73, v73
    v_exp_f32 v74, v74
    v_exp_f32 v75, v75
    v_mfma_f32_32x32x16_bf16 v[96:111], v[44:47], v[84:87], v[96:111]
    v_cvt_pk_bf16_f32 v92, v72, v73
    v_cvt_pk_bf16_f32 v93, v74, v75
    v_exp_f32 v76, v76
    v_exp_f32 v77, v77
    v_exp_f32 v78, v78
    v_exp_f32 v79, v79
    v_cvt_pk_bf16_f32 v94, v76, v77
    v_cvt_pk_bf16_f32 v95, v78, v79
    v_mfma_f32_32x32x8_bf16 v[64:79], v[24:25], v[18:19], 0
    v_exp_f32 v48, v48
    v_exp_f32 v49, v49
    v_exp_f32 v50, v50
    v_exp_f32 v51, v51
    v_mfma_f32_32x32x16_bf16 v[64:79], v[20:23], v[14:17], v[64:79]
    ds_read_b128 v[26:29], v5 offset:21312
    v_cvt_pk_bf16_f32 v80, v48, v49
    v_cvt_pk_bf16_f32 v81, v50, v51
    v_exp_f32 v52, v52
    v_exp_f32 v53, v53
    v_exp_f32 v54, v54
    v_exp_f32 v55, v55
    v_mfma_f32_32x32x16_bf16 v[112:127], v[40:43], v[88:91], v[112:127]
    ds_read_b32 v30, v6 offset:21312
    v_cvt_pk_bf16_f32 v82, v52, v53
    v_cvt_pk_bf16_f32 v83, v54, v55
    v_exp_f32 v56, v56
    v_exp_f32 v57, v57
    v_exp_f32 v58, v58
    v_exp_f32 v59, v59
    v_mfma_f32_32x32x16_bf16 v[112:127], v[44:47], v[92:95], v[112:127]
    v_cvt_pk_bf16_f32 v84, v56, v57
    v_cvt_pk_bf16_f32 v85, v58, v59
    v_exp_f32 v60, v60
    v_exp_f32 v61, v61
    v_exp_f32 v62, v62
    v_exp_f32 v63, v63
    v_cvt_pk_bf16_f32 v86, v60, v61
    v_cvt_pk_bf16_f32 v87, v62, v63
    s_waitcnt lgkmcnt(0)
    v_mfma_f32_32x32x8_bf16 v[48:63], v[30:31], v[12:13], 0
    v_exp_f32 v64, v64
    v_exp_f32 v65, v65
    v_exp_f32 v66, v66
    v_exp_f32 v67, v67
    v_mfma_f32_32x32x16_bf16 v[48:63], v[26:29], v[8:11], v[48:63]
    ds_read_b128 v[40:43], v7 offset:21312
    v_cvt_pk_bf16_f32 v88, v64, v65
    v_cvt_pk_bf16_f32 v89, v66, v67
    v_exp_f32 v68, v68
    v_exp_f32 v69, v69
    v_exp_f32 v70, v70
    v_exp_f32 v71, v71
    v_mfma_f32_32x32x16_bf16 v[96:111], v[32:35], v[80:83], v[96:111]
    ds_read_b128 v[44:47], v7 offset:21920
    v_cvt_pk_bf16_f32 v90, v68, v69
    v_cvt_pk_bf16_f32 v91, v70, v71
    v_exp_f32 v72, v72
    v_exp_f32 v73, v73
    v_exp_f32 v74, v74
    v_exp_f32 v75, v75
    v_mfma_f32_32x32x16_bf16 v[96:111], v[36:39], v[84:87], v[96:111]
    v_cvt_pk_bf16_f32 v92, v72, v73
    v_cvt_pk_bf16_f32 v93, v74, v75
    v_exp_f32 v76, v76
    v_exp_f32 v77, v77
    v_exp_f32 v78, v78
    v_exp_f32 v79, v79
    v_cvt_pk_bf16_f32 v94, v76, v77
    v_cvt_pk_bf16_f32 v95, v78, v79
    v_mfma_f32_32x32x8_bf16 v[64:79], v[30:31], v[18:19], 0
    v_exp_f32 v48, v48
    v_exp_f32 v49, v49
    v_exp_f32 v50, v50
    v_exp_f32 v51, v51
    v_mfma_f32_32x32x16_bf16 v[64:79], v[26:29], v[14:17], v[64:79]
    ds_read_b128 v[20:23], v5 offset:23680
    v_cvt_pk_bf16_f32 v80, v48, v49
    v_cvt_pk_bf16_f32 v81, v50, v51
    v_exp_f32 v52, v52
    v_exp_f32 v53, v53
    v_exp_f32 v54, v54
    v_exp_f32 v55, v55
    v_mfma_f32_32x32x16_bf16 v[112:127], v[32:35], v[88:91], v[112:127]
    ds_read_b32 v24, v6 offset:23680
    v_cvt_pk_bf16_f32 v82, v52, v53
    v_cvt_pk_bf16_f32 v83, v54, v55
    v_exp_f32 v56, v56
    v_exp_f32 v57, v57
    v_exp_f32 v58, v58
    v_exp_f32 v59, v59
    v_mfma_f32_32x32x16_bf16 v[112:127], v[36:39], v[92:95], v[112:127]
    v_cvt_pk_bf16_f32 v84, v56, v57
    v_cvt_pk_bf16_f32 v85, v58, v59
    v_exp_f32 v60, v60
    v_exp_f32 v61, v61
    v_exp_f32 v62, v62
    v_exp_f32 v63, v63
    v_cvt_pk_bf16_f32 v86, v60, v61
    v_cvt_pk_bf16_f32 v87, v62, v63
    s_waitcnt lgkmcnt(0)
    v_mfma_f32_32x32x8_bf16 v[48:63], v[24:25], v[12:13], 0
    v_exp_f32 v64, v64
    v_exp_f32 v65, v65
    v_exp_f32 v66, v66
    v_exp_f32 v67, v67
    v_mfma_f32_32x32x16_bf16 v[48:63], v[20:23], v[8:11], v[48:63]
    ds_read_b128 v[32:35], v7 offset:23680
    v_cvt_pk_bf16_f32 v88, v64, v65
    v_cvt_pk_bf16_f32 v89, v66, v67
    v_exp_f32 v68, v68
    v_exp_f32 v69, v69
    v_exp_f32 v70, v70
    v_exp_f32 v71, v71
    v_mfma_f32_32x32x16_bf16 v[96:111], v[40:43], v[80:83], v[96:111]
    ds_read_b128 v[36:39], v7 offset:24288
    v_cvt_pk_bf16_f32 v90, v68, v69
    v_cvt_pk_bf16_f32 v91, v70, v71
    v_exp_f32 v72, v72
    v_exp_f32 v73, v73
    v_exp_f32 v74, v74
    v_exp_f32 v75, v75
    v_mfma_f32_32x32x16_bf16 v[96:111], v[44:47], v[84:87], v[96:111]
    v_cvt_pk_bf16_f32 v92, v72, v73
    v_cvt_pk_bf16_f32 v93, v74, v75
    v_exp_f32 v76, v76
    v_exp_f32 v77, v77
    v_exp_f32 v78, v78
    v_exp_f32 v79, v79
    v_cvt_pk_bf16_f32 v94, v76, v77
    v_cvt_pk_bf16_f32 v95, v78, v79
    v_mfma_f32_32x32x8_bf16 v[64:79], v[24:25], v[18:19], 0
    v_exp_f32 v48, v48
    v_exp_f32 v49, v49
    v_exp_f32 v50, v50
    v_exp_f32 v51, v51
    v_mfma_f32_32x32x16_bf16 v[64:79], v[20:23], v[14:17], v[64:79]
    ds_read_b128 v[26:29], v5 offset:26048
    v_cvt_pk_bf16_f32 v80, v48, v49
    v_cvt_pk_bf16_f32 v81, v50, v51
    v_exp_f32 v52, v52
    v_exp_f32 v53, v53
    v_exp_f32 v54, v54
    v_exp_f32 v55, v55
    v_mfma_f32_32x32x16_bf16 v[112:127], v[40:43], v[88:91], v[112:127]
    ds_read_b32 v30, v6 offset:26048
    v_cvt_pk_bf16_f32 v82, v52, v53
    v_cvt_pk_bf16_f32 v83, v54, v55
    v_exp_f32 v56, v56
    v_exp_f32 v57, v57
    v_exp_f32 v58, v58
    v_exp_f32 v59, v59
    v_mfma_f32_32x32x16_bf16 v[112:127], v[44:47], v[92:95], v[112:127]
    v_cvt_pk_bf16_f32 v84, v56, v57
    v_cvt_pk_bf16_f32 v85, v58, v59
    v_exp_f32 v60, v60
    v_exp_f32 v61, v61
    v_exp_f32 v62, v62
    v_exp_f32 v63, v63
    v_cvt_pk_bf16_f32 v86, v60, v61
    v_cvt_pk_bf16_f32 v87, v62, v63
    s_waitcnt lgkmcnt(0)
    v_mfma_f32_32x32x8_bf16 v[48:63], v[30:31], v[12:13], 0
    v_exp_f32 v64, v64
    v_exp_f32 v65, v65
    v_exp_f32 v66, v66
    v_exp_f32 v67, v67
    v_mfma_f32_32x32x16_bf16 v[48:63], v[26:29], v[8:11], v[48:63]
    ds_read_b128 v[40:43], v7 offset:26048
    v_cvt_pk_bf16_f32 v88, v64, v65
    v_cvt_pk_bf16_f32 v89, v66, v67
    v_exp_f32 v68, v68
    v_exp_f32 v69, v69
    v_exp_f32 v70, v70
    v_exp_f32 v71, v71
    v_mfma_f32_32x32x16_bf16 v[96:111], v[32:35], v[80:83], v[96:111]
    ds_read_b128 v[44:47], v7 offset:26656
    v_cvt_pk_bf16_f32 v90, v68, v69
    v_cvt_pk_bf16_f32 v91, v70, v71
    v_exp_f32 v72, v72
    v_exp_f32 v73, v73
    v_exp_f32 v74, v74
    v_exp_f32 v75, v75
    v_mfma_f32_32x32x16_bf16 v[96:111], v[36:39], v[84:87], v[96:111]
    v_cvt_pk_bf16_f32 v92, v72, v73
    v_cvt_pk_bf16_f32 v93, v74, v75
    v_exp_f32 v76, v76
    v_exp_f32 v77, v77
    v_exp_f32 v78, v78
    v_exp_f32 v79, v79
    v_cvt_pk_bf16_f32 v94, v76, v77
    v_cvt_pk_bf16_f32 v95, v78, v79
    v_mfma_f32_32x32x8_bf16 v[64:79], v[30:31], v[18:19], 0
    v_exp_f32 v48, v48
    v_exp_f32 v49, v49
    v_exp_f32 v50, v50
    v_exp_f32 v51, v51
    v_mfma_f32_32x32x16_bf16 v[64:79], v[26:29], v[14:17], v[64:79]
    ds_read_b128 v[20:23], v5 offset:28416
    v_cvt_pk_bf16_f32 v80, v48, v49
    v_cvt_pk_bf16_f32 v81, v50, v51
    v_exp_f32 v52, v52
    v_exp_f32 v53, v53
    v_exp_f32 v54, v54
    v_exp_f32 v55, v55
    v_mfma_f32_32x32x16_bf16 v[112:127], v[32:35], v[88:91], v[112:127]
    ds_read_b32 v24, v6 offset:28416
    v_cvt_pk_bf16_f32 v82, v52, v53
    v_cvt_pk_bf16_f32 v83, v54, v55
    v_exp_f32 v56, v56
    v_exp_f32 v57, v57
    v_exp_f32 v58, v58
    v_exp_f32 v59, v59
    v_mfma_f32_32x32x16_bf16 v[112:127], v[36:39], v[92:95], v[112:127]
    v_cvt_pk_bf16_f32 v84, v56, v57
    v_cvt_pk_bf16_f32 v85, v58, v59
    v_exp_f32 v60, v60
    v_exp_f32 v61, v61
    v_exp_f32 v62, v62
    v_exp_f32 v63, v63
    v_cvt_pk_bf16_f32 v86, v60, v61
    v_cvt_pk_bf16_f32 v87, v62, v63
    s_waitcnt lgkmcnt(0)
    v_mfma_f32_32x32x8_bf16 v[48:63], v[24:25], v[12:13], 0
    v_exp_f32 v64, v64
    v_exp_f32 v65, v65
    v_exp_f32 v66, v66
    v_exp_f32 v67, v67
    v_mfma_f32_32x32x16_bf16 v[48:63], v[20:23], v[8:11], v[48:63]
    ds_read_b128 v[32:35], v7 offset:28416
    v_cvt_pk_bf16_f32 v88, v64, v65
    v_cvt_pk_bf16_f32 v89, v66, v67
    v_exp_f32 v68, v68
    v_exp_f32 v69, v69
    v_exp_f32 v70, v70
    v_exp_f32 v71, v71
    v_mfma_f32_32x32x16_bf16 v[96:111], v[40:43], v[80:83], v[96:111]
    ds_read_b128 v[36:39], v7 offset:29024
    v_cvt_pk_bf16_f32 v90, v68, v69
    v_cvt_pk_bf16_f32 v91, v70, v71
    v_exp_f32 v72, v72
    v_exp_f32 v73, v73
    v_exp_f32 v74, v74
    v_exp_f32 v75, v75
    v_mfma_f32_32x32x16_bf16 v[96:111], v[44:47], v[84:87], v[96:111]
    v_cvt_pk_bf16_f32 v92, v72, v73
    v_cvt_pk_bf16_f32 v93, v74, v75
    v_exp_f32 v76, v76
    v_exp_f32 v77, v77
    v_exp_f32 v78, v78
    v_exp_f32 v79, v79
    v_cvt_pk_bf16_f32 v94, v76, v77
    v_cvt_pk_bf16_f32 v95, v78, v79
    v_mfma_f32_32x32x8_bf16 v[64:79], v[24:25], v[18:19], 0
    v_exp_f32 v48, v48
    v_exp_f32 v49, v49
    v_exp_f32 v50, v50
    v_exp_f32 v51, v51
    v_mfma_f32_32x32x16_bf16 v[64:79], v[20:23], v[14:17], v[64:79]
    ds_read_b128 v[26:29], v5 offset:30784
    v_cvt_pk_bf16_f32 v80, v48, v49
    v_cvt_pk_bf16_f32 v81, v50, v51
    v_exp_f32 v52, v52
    v_exp_f32 v53, v53
    v_exp_f32 v54, v54
    v_exp_f32 v55, v55
    v_mfma_f32_32x32x16_bf16 v[112:127], v[40:43], v[88:91], v[112:127]
    ds_read_b32 v30, v6 offset:30784
    v_cvt_pk_bf16_f32 v82, v52, v53
    v_cvt_pk_bf16_f32 v83, v54, v55
    v_exp_f32 v56, v56
    v_exp_f32 v57, v57
    v_exp_f32 v58, v58
    v_exp_f32 v59, v59
    v_mfma_f32_32x32x16_bf16 v[112:127], v[44:47], v[92:95], v[112:127]
    v_cvt_pk_bf16_f32 v84, v56, v57
    v_cvt_pk_bf16_f32 v85, v58, v59
    v_exp_f32 v60, v60
    v_exp_f32 v61, v61
    v_exp_f32 v62, v62
    v_exp_f32 v63, v63
    v_cvt_pk_bf16_f32 v86, v60, v61
    v_cvt_pk_bf16_f32 v87, v62, v63
    s_waitcnt lgkmcnt(0)
    v_mfma_f32_32x32x8_bf16 v[48:63], v[30:31], v[12:13], 0
    v_exp_f32 v64, v64
    v_exp_f32 v65, v65
    v_exp_f32 v66, v66
    v_exp_f32 v67, v67
    v_mfma_f32_32x32x16_bf16 v[48:63], v[26:29], v[8:11], v[48:63]
    ds_read_b128 v[40:43], v7 offset:30784
    v_cvt_pk_bf16_f32 v88, v64, v65
    v_cvt_pk_bf16_f32 v89, v66, v67
    v_exp_f32 v68, v68
    v_exp_f32 v69, v69
    v_exp_f32 v70, v70
    v_exp_f32 v71, v71
    v_mfma_f32_32x32x16_bf16 v[96:111], v[32:35], v[80:83], v[96:111]
    ds_read_b128 v[44:47], v7 offset:31392
    v_cvt_pk_bf16_f32 v90, v68, v69
    v_cvt_pk_bf16_f32 v91, v70, v71
    v_exp_f32 v72, v72
    v_exp_f32 v73, v73
    v_exp_f32 v74, v74
    v_exp_f32 v75, v75
    v_mfma_f32_32x32x16_bf16 v[96:111], v[36:39], v[84:87], v[96:111]
    v_cvt_pk_bf16_f32 v92, v72, v73
    v_cvt_pk_bf16_f32 v93, v74, v75
    v_exp_f32 v76, v76
    v_exp_f32 v77, v77
    v_exp_f32 v78, v78
    v_exp_f32 v79, v79
    v_cvt_pk_bf16_f32 v94, v76, v77
    v_cvt_pk_bf16_f32 v95, v78, v79
    s_cmp_lg_u32 s8, 3
    s_cbranch_scc1 L_kb_npr
    s_setprio 0
L_kb_npr:
    v_mfma_f32_32x32x8_bf16 v[64:79], v[30:31], v[18:19], 0
    v_exp_f32 v48, v48
    v_exp_f32 v49, v49
    v_exp_f32 v50, v50
    v_exp_f32 v51, v51
    v_mfma_f32_32x32x16_bf16 v[64:79], v[26:29], v[14:17], v[64:79]
    ds_read_b128 v[20:23], v5 offset:33152
    v_cvt_pk_bf16_f32 v80, v48, v49
    v_cvt_pk_bf16_f32 v81, v50, v51
    v_exp_f32 v52, v52
    v_exp_f32 v53, v53
    v_exp_f32 v54, v54
    v_exp_f32 v55, v55
    v_mfma_f32_32x32x16_bf16 v[112:127], v[32:35], v[88:91], v[112:127]
    ds_read_b32 v24, v6 offset:33152
    v_cvt_pk_bf16_f32 v82, v52, v53
    v_cvt_pk_bf16_f32 v83, v54, v55
    v_exp_f32 v56, v56
    v_exp_f32 v57, v57
    v_exp_f32 v58, v58
    v_exp_f32 v59, v59
    v_mfma_f32_32x32x16_bf16 v[112:127], v[36:39], v[92:95], v[112:127]
    v_cvt_pk_bf16_f32 v84, v56, v57
    v_cvt_pk_bf16_f32 v85, v58, v59
    v_exp_f32 v60, v60
    v_exp_f32 v61, v61
    v_exp_f32 v62, v62
    v_exp_f32 v63, v63
    v_cvt_pk_bf16_f32 v86, v60, v61
    v_cvt_pk_bf16_f32 v87, v62, v63
    s_waitcnt lgkmcnt(0)
    v_mfma_f32_32x32x8_bf16 v[48:63], v[24:25], v[12:13], 0
    v_exp_f32 v64, v64
    v_exp_f32 v65, v65
    v_exp_f32 v66, v66
    v_exp_f32 v67, v67
    v_mfma_f32_32x32x16_bf16 v[48:63], v[20:23], v[8:11], v[48:63]
    ds_read_b128 v[32:35], v7 offset:33152
    v_cvt_pk_bf16_f32 v88, v64, v65
    v_cvt_pk_bf16_f32 v89, v66, v67
    v_exp_f32 v68, v68
    v_exp_f32 v69, v69
    v_exp_f32 v70, v70
    v_exp_f32 v71, v71
    v_mfma_f32_32x32x16_bf16 v[96:111], v[40:43], v[80:83], v[96:111]
    ds_read_b128 v[36:39], v7 offset:33760
    v_cvt_pk_bf16_f32 v90, v68, v69
    v_cvt_pk_bf16_f32 v91, v70, v71
    v_exp_f32 v72, v72
    v_exp_f32 v73, v73
    v_exp_f32 v74, v74
    v_exp_f32 v75, v75
    v_mfma_f32_32x32x16_bf16 v[96:111], v[44:47], v[84:87], v[96:111]
    v_cvt_pk_bf16_f32 v92, v72, v73
    v_cvt_pk_bf16_f32 v93, v74, v75
    v_exp_f32 v76, v76
    v_exp_f32 v77, v77
    v_exp_f32 v78, v78
    v_exp_f32 v79, v79
    v_cvt_pk_bf16_f32 v94, v76, v77
    v_cvt_pk_bf16_f32 v95, v78, v79
    v_mfma_f32_32x32x8_bf16 v[64:79], v[24:25], v[18:19], 0
    v_exp_f32 v48, v48
    v_exp_f32 v49, v49
    v_exp_f32 v50, v50
    v_exp_f32 v51, v51
    v_mfma_f32_32x32x16_bf16 v[64:79], v[20:23], v[14:17], v[64:79]
    ds_read_b128 v[26:29], v5 offset:35520
    v_cvt_pk_bf16_f32 v80, v48, v49
    v_cvt_pk_bf16_f32 v81, v50, v51
    v_exp_f32 v52, v52
    v_exp_f32 v53, v53
    v_exp_f32 v54, v54
    v_exp_f32 v55, v55
    v_mfma_f32_32x32x16_bf16 v[112:127], v[40:43], v[88:91], v[112:127]
    ds_read_b32 v30, v6 offset:35520
    v_cvt_pk_bf16_f32 v82, v52, v53
    v_cvt_pk_bf16_f32 v83, v54, v55
    v_exp_f32 v56, v56
    v_exp_f32 v57, v57
    v_exp_f32 v58, v58
    v_exp_f32 v59, v59
    v_mfma_f32_32x32x16_bf16 v[112:127], v[44:47], v[92:95], v[112:127]
    v_cvt_pk_bf16_f32 v84, v56, v57
    v_cvt_pk_bf16_f32 v85, v58, v59
    v_exp_f32 v60, v60
    v_exp_f32 v61, v61
    v_exp_f32 v62, v62
    v_exp_f32 v63, v63
    v_cvt_pk_bf16_f32 v86, v60, v61
    v_cvt_pk_bf16_f32 v87, v62, v63
    s_waitcnt lgkmcnt(0)
    v_mfma_f32_32x32x8_bf16 v[48:63], v[30:31], v[12:13], 0
    v_exp_f32 v64, v64
    v_exp_f32 v65, v65
    v_exp_f32 v66, v66
    v_exp_f32 v67, v67
    v_mfma_f32_32x32x16_bf16 v[48:63], v[26:29], v[8:11], v[48:63]
    ds_read_b128 v[40:43], v7 offset:35520
    v_cvt_pk_bf16_f32 v88, v64, v65
    v_cvt_pk_bf16_f32 v89, v66, v67
    v_exp_f32 v68, v68
    v_exp_f32 v69, v69
    v_exp_f32 v70, v70
    v_exp_f32 v71, v71
    v_mfma_f32_32x32x16_bf16 v[96:111], v[32:35], v[80:83], v[96:111]
    ds_read_b128 v[44:47], v7 offset:36128
    v_cvt_pk_bf16_f32 v90, v68, v69
    v_cvt_pk_bf16_f32 v91, v70, v71
    v_exp_f32 v72, v72
    v_exp_f32 v73, v73
    v_exp_f32 v74, v74
    v_exp_f32 v75, v75
    v_mfma_f32_32x32x16_bf16 v[96:111], v[36:39], v[84:87], v[96:111]
    v_cvt_pk_bf16_f32 v92, v72, v73
    v_cvt_pk_bf16_f32 v93, v74, v75
    v_exp_f32 v76, v76
    v_exp_f32 v77, v77
    v_exp_f32 v78, v78
    v_exp_f32 v79, v79
    v_cvt_pk_bf16_f32 v94, v76, v77
    v_cvt_pk_bf16_f32 v95, v78, v79
    v_mfma_f32_32x32x8_bf16 v[64:79], v[30:31], v[18:19], 0
    v_exp_f32 v48, v48
    v_exp_f32 v49, v49
    v_exp_f32 v50, v50
    v_exp_f32 v51, v51
    v_mfma_f32_32x32x16_bf16 v[64:79], v[26:29], v[14:17], v[64:79]
    v_cvt_pk_bf16_f32 v80, v48, v49
    v_cvt_pk_bf16_f32 v81, v50, v51
    v_exp_f32 v52, v52
    v_exp_f32 v53, v53
    v_exp_f32 v54, v54
    v_exp_f32 v55, v55
    v_mfma_f32_32x32x16_bf16 v[112:127], v[32:35], v[88:91], v[112:127]
    v_cvt_pk_bf16_f32 v82, v52, v53
    v_cvt_pk_bf16_f32 v83, v54, v55
    v_exp_f32 v56, v56
    v_exp_f32 v57, v57
    v_exp_f32 v58, v58
    v_exp_f32 v59, v59
    v_mfma_f32_32x32x16_bf16 v[112:127], v[36:39], v[92:95], v[112:127]
    v_cvt_pk_bf16_f32 v84, v56, v57
    v_cvt_pk_bf16_f32 v85, v58, v59
    v_exp_f32 v60, v60
    v_exp_f32 v61, v61
    v_exp_f32 v62, v62
    v_exp_f32 v63, v63
    v_cvt_pk_bf16_f32 v86, v60, v61
    v_cvt_pk_bf16_f32 v87, v62, v63
    s_waitcnt lgkmcnt(0)
    v_exp_f32 v64, v64
    v_exp_f32 v65, v65
    v_exp_f32 v66, v66
    v_exp_f32 v67, v67
    s_nop 0
    v_cvt_pk_bf16_f32 v88, v64, v65
    v_cvt_pk_bf16_f32 v89, v66, v67
    v_exp_f32 v68, v68
    v_exp_f32 v69, v69
    v_exp_f32 v70, v70
    v_exp_f32 v71, v71
    v_mfma_f32_32x32x16_bf16 v[96:111], v[40:43], v[80:83], v[96:111]
    v_cvt_pk_bf16_f32 v90, v68, v69
    v_cvt_pk_bf16_f32 v91, v70, v71
    v_exp_f32 v72, v72
    v_exp_f32 v73, v73
    v_exp_f32 v74, v74
    v_exp_f32 v75, v75
    v_mfma_f32_32x32x16_bf16 v[96:111], v[44:47], v[84:87], v[96:111]
    v_cvt_pk_bf16_f32 v92, v72, v73
    v_cvt_pk_bf16_f32 v93, v74, v75
    v_exp_f32 v76, v76
    v_exp_f32 v77, v77
    v_exp_f32 v78, v78
    v_exp_f32 v79, v79
    v_cvt_pk_bf16_f32 v94, v76, v77
    v_cvt_pk_bf16_f32 v95, v78, v79
    s_nop 1
    v_mfma_f32_32x32x16_bf16 v[112:127], v[40:43], v[88:91], v[112:127]
    v_mfma_f32_32x32x16_bf16 v[112:127], v[44:47], v[92:95], v[112:127]
    s_cmp_lt_u32 s8, 2
    s_cbranch_scc1 L_kb_early
    s_sub_u32 s9, 3, s8
    s_lshl_b32 s10, s9, 4
    s_add_u32 s10, s10, 163392
    v_mov_b32 v8, s10
    s_mul_i32 s9, s9, 37888
    s_mul_i32 s10, s7, 9472
    s_add_u32 s9, s9, s10
    s_add_u32 s9, s9, 6144
    v_add_u32 v5, s9, v1
    s_mov_b32 s11, 262144
L_kb_lspin:
    ds_read_b128 v[12:15], v8
    s_waitcnt lgkmcnt(0)
    v_xor_b32 v12, s3, v12
    v_xor_b32 v13, s3, v13
    v_xor_b32 v14, s3, v14
    v_xor_b32 v15, s3, v15
    v_or3_b32 v12, v12, v13, v14
    v_or_b32 v12, v12, v15
    v_cmp_ne_u32 vcc, 0, v12
    s_cbranch_vccz L_kb_lok
    s_sleep 2
    s_sub_u32 s11, s11, 1
    s_cmp_lg_u32 s11, 0
    s_cbranch_scc1 L_kb_lspin
L_kb_lok:
    s_cmp_eq_u32 s8, 3
    s_cbranch_scc1 L_kb_dep3
    ds_write_b128 v5, v[96:99]
    ds_write_b128 v5, v[100:103] offset:1024
    ds_write_b128 v5, v[104:107] offset:2048
    v_mov_b32 v48, v112
    v_mov_b32 v49, v113
    v_mov_b32 v50, v114
    v_mov_b32 v51, v115
    v_mov_b32 v52, v116
    v_mov_b32 v53, v117
    v_mov_b32 v54, v118
    v_mov_b32 v55, v119
    v_mov_b32 v56, v120
    v_mov_b32 v57, v121
    v_mov_b32 v58, v122
    s_branch L_kb_b3
L_kb_dep3:
    ds_write_b128 v5, v[112:115]
    ds_write_b128 v5, v[116:119] offset:1024
    ds_write_b128 v5, v[120:123] offset:2048
    v_mov_b32 v48, v96
    v_mov_b32 v49, v97
    v_mov_b32 v50, v98
    v_mov_b32 v51, v99
    v_mov_b32 v52, v100
    v_mov_b32 v53, v101
    v_mov_b32 v54, v102
    v_mov_b32 v55, v103
    v_mov_b32 v56, v104
    v_mov_b32 v57, v105
    v_mov_b32 v58, v106
    s_branch L_kb_b3
L_kb_early:
    s_setprio 3
    v_and_b32 v3, 15, v2
    v_lshrrev_b32 v4, 4, v2
    s_lshl_b32 s9, s6, 2
    s_add_u32 s9, s9, 163392
    v_mov_b32 v8, s9
    v_mov_b32 v9, s3
    ds_write_b32 v8, v9
    s_lshl_b32 s9, s8, 4
    s_add_u32 s9, s9, 163392
    v_mov_b32 v8, s9
    s_mov_b32 s11, 262144
L_kb_qspin:
    ds_read_b128 v[12:15], v8
    s_waitcnt lgkmcnt(0)
    v_xor_b32 v12, s3, v12
    v_xor_b32 v13, s3, v13
    v_xor_b32 v14, s3, v14
    v_xor_b32 v15, s3, v15
    v_or3_b32 v12, v12, v13, v14
    v_or_b32 v12, v12, v15
    v_cmp_ne_u32 vcc, 0, v12
    s_cbranch_vccz L_kb_qok
    s_sleep 2
    s_sub_u32 s11, s11, 1
    s_cmp_lg_u32 s11, 0
    s_cbranch_scc1 L_kb_qspin
L_kb_qok:
    s_cmp_ge_u32 s8, 2
    s_cbranch_scc1 L_kb_deposit
    s_cmp_ge_u32 s2, 216
    s_cbranch_scc1 L_kb_deposit
    v_lshrrev_b32 v84, 1, v2
    v_and_b32 v85, 1, v2
    v_lshlrev_b32 v85, 4, v85
    v_and_b32 v87, 1, v3
    v_mul_u32_u24 v87, 1152, v87
    v_lshl_add_u32 v87, v4, 4, v87
    s_lshl_b32 s45, s38, 6
    s_add_u32 s45, s45, 16384
    v_lshlrev_b32 v89, 8, v4
    v_lshl_add_u32 v89, v3, 3, v89
    v_add_u32 v89, s47, v89
    s_mov_b32 s50, 294912
    s_mov_b32 s51, 9216
    s_cmp_eq_u32 s8, 0
    s_cbranch_scc1 L_kb_sgo
    s_mov_b32 s16, s56
    s_mov_b32 s17, s57
    s_mov_b32 s44, s48
    s_mov_b32 s46, s49
    s_mov_b32 s50, 36864
    s_mov_b32 s51, 1152
L_kb_sgo:
    v_mul_lo_u32 v86, s51, v84
    v_add_u32 v86, v86, v85
    s_add_u32 s11, s47, 0
    s_mov_b32 m0, s11
    s_nop 0
    buffer_load_dwordx4 v86, s[16:19], s44 offen lds
    s_add_u32 s44, s44, s50
    s_add_u32 s11, s47, 1024
    s_mov_b32 m0, s11
    s_nop 0
    buffer_load_dwordx4 v86, s[16:19], s44 offen lds
    s_add_u32 s44, s44, s50
    s_add_u32 s11, s47, 2048
    s_mov_b32 m0, s11
    s_nop 0
    buffer_load_dwordx4 v86, s[16:19], s44 offen lds
    s_add_u32 s44, s44, s50
    s_add_u32 s11, s47, 3072
    s_mov_b32 m0, s11
    s_nop 0
    buffer_load_dwordx4 v86, s[16:19], s44 offen lds
    s_add_u32 s44, s44, s50
    s_add_u32 s11, s47, 4096
    s_mov_b32 m0, s11
    s_nop 0
    buffer_load_dwordx4 v86, s[16:19], s44 offen lds
    s_add_u32 s44, s44, s50
    s_add_u32 s11, s47, 5120
    s_mov_b32 m0, s11
    s_nop 0
    buffer_load_dwordx4 v86, s[16:19], s44 offen lds
    s_add_u32 s44, s44, s50
    buffer_load_dwordx4 v[56:59], v87, s[12:15], s45 offen offset:0 sc1
    buffer_load_dwordx4 v[60:63], v87, s[12:15], s45 offen offset:64 sc1
    buffer_load_dwordx4 v[64:67], v87, s[12:15], s45 offen offset:128 sc1
    buffer_load_dwordx4 v[68:71], v87, s[12:15], s45 offen offset:192 sc1
    buffer_load_dwordx4 v[72:75], v87, s[12:15], s45 offen offset:256 sc1
    buffer_load_dwordx4 v[76:79], v87, s[12:15], s45 offen offset:320 sc1
    s_waitcnt vmcnt(0)
    ds_read_b64_tr_b16 v[8:9], v89 offset:0
    ds_read_b64_tr_b16 v[10:11], v89 offset:128
    ds_read_b64_tr_b16 v[12:13], v89 offset:1024
    ds_read_b64_tr_b16 v[14:15], v89 offset:1152
    ds_read_b64_tr_b16 v[16:17], v89 offset:2048
    ds_read_b64_tr_b16 v[18:19], v89 offset:2176
    ds_read_b64_tr_b16 v[20:21], v89 offset:3072
    ds_read_b64_tr_b16 v[22:23], v89 offset:3200
    ds_read_b64_tr_b16 v[24:25], v89 offset:4096
    ds_read_b64_tr_b16 v[26:27], v89 offset:4224
    ds_read_b64_tr_b16 v[28:29], v89 offset:5120
    ds_read_b64_tr_b16 v[30:31], v89 offset:5248
    s_waitcnt lgkmcnt(10)
    buffer_store_dwordx4 v[8:11], v1, s[12:15], s46 offen offset:0 sc1
    v_mfma_f32_16x16x32_bf16 v[80:83], v[8:11], v[56:59], 0
    s_waitcnt lgkmcnt(8)
    buffer_store_dwordx4 v[12:15], v1, s[12:15], s46 offen offset:1024 sc1
    v_mfma_f32_16x16x32_bf16 v[80:83], v[12:15], v[60:63], v[80:83]
    s_waitcnt lgkmcnt(6)
    buffer_store_dwordx4 v[16:19], v1, s[12:15], s46 offen offset:2048 sc1
    v_mfma_f32_16x16x32_bf16 v[80:83], v[16:19], v[64:67], v[80:83]
    s_waitcnt lgkmcnt(4)
    buffer_store_dwordx4 v[20:23], v1, s[12:15], s46 offen offset:3072 sc1
    v_mfma_f32_16x16x32_bf16 v[80:83], v[20:23], v[68:71], v[80:83]
    s_waitcnt lgkmcnt(2)
    s_add_u32 s46, s46, 4096
    buffer_store_dwordx4 v[24:27], v1, s[12:15], s46 offen offset:0 sc1
    v_mfma_f32_16x16x32_bf16 v[80:83], v[24:27], v[72:75], v[80:83]
    s_waitcnt lgkmcnt(0)
    buffer_store_dwordx4 v[28:31], v1, s[12:15], s46 offen offset:1024 sc1
    v_mfma_f32_16x16x32_bf16 v[80:83], v[28:31], v[76:79], v[80:83]
    s_cmp_eq_u32 s8, 1
    s_cbranch_scc1 L_kb_deposit
    v_lshlrev_b32 v86, 7, v4
    v_lshl_add_u32 v86, v3, 2, v86
    s_lshl_b32 s46, s36, 9
    s_lshl_b32 s9, s37, 3
    s_add_u32 s46, s46, s9
    s_add_u32 s46, s46, 32768
    v_cmp_gt_u32 vcc, 2, v3
    s_and_saveexec_b64 s[34:35], vcc
    s_nop 3
    buffer_store_dword v80, v86, s[12:15], s46 offen sc1
    buffer_store_dword v81, v86, s[12:15], s46 offen offset:32 sc1
    buffer_store_dword v82, v86, s[12:15], s46 offen offset:64 sc1
    buffer_store_dword v83, v86, s[12:15], s46 offen offset:96 sc1
    s_mov_b64 exec, s[34:35]
L_kb_deposit:
    v_add_u32 v5, s47, v1
    ds_write_b128 v5, v[96:99]
    ds_write_b128 v5, v[100:103] offset:1024
    ds_write_b128 v5, v[112:115] offset:2048
    ds_write_b128 v5, v[116:119] offset:3072
    ds_write_b128 v5, v[104:107] offset:4096
    ds_write_b128 v5, v[120:123] offset:5120
    s_waitcnt lgkmcnt(0)
    s_cmp_ge_u32 s8, 2
    s_cbranch_scc1 L_kb_nofs
    s_waitcnt vmcnt(0)
    s_lshl_b32 s9, s6, 2
    s_add_u32 s9, s9, 163424
    v_mov_b32 v8, s9
    v_mov_b32 v9, s3
    ds_write_b32 v8, v9
    s_lshl_b32 s9, s8, 4
    s_add_u32 s9, s9, 163424
    v_mov_b32 v8, s9
    ds_read_b128 v[12:15], v8
    s_waitcnt lgkmcnt(0)
    v_xor_b32 v12, s3, v12
    v_xor_b32 v13, s3, v13
    v_xor_b32 v14, s3, v14
    v_xor_b32 v15, s3, v15
    v_or3_b32 v12, v12, v13, v14
    v_or_b32 v12, v12, v15
    v_cmp_ne_u32 vcc, 0, v12
    s_lshl_b32 s10, s20, 7
    s_lshl_b32 s11, s21, 2
    s_add_u32 s10, s10, s11
    s_mul_i32 s11, s8, 65536
    s_add_u32 s10, s10, s11
    s_add_u32 s10, s10, 278528
    s_cbranch_vccnz L_kb_nofs
    v_mov_b32 v120, s3
    v_mov_b32 v121, 0
    s_mov_b64 exec, 1
    buffer_store_dword v120, v121, s[12:15], s10 offen sc1
    s_mov_b64 exec, -1
L_kb_nofs:
    s_cmp_ge_u32 s6, 3
    s_cbranch_scc1 L_kb_noax
    s_mul_i32 s9, s23, 27
    v_add_u32 v5, s9, v2
    v_lshrrev_b32 v6, 2, v5
    v_and_b32 v5, 3, v5
    v_lshlrev_b32 v5, 2, v5
    v_lshl_add_u32 v6, v6, 7, v5
    v_lshlrev_b32 v5, 7, v2
    s_mov_b32 s10, 278528
    s_mov_b64 exec, 0x7ffffff
    s_mov_b32 s11, 262144
L_adaLN_cond__grouped_kv_mqa__dense_activation_relu__prompt_kernel_fs_2:
    buffer_load_dword v120, v6, s[12:15], s10 offen sc1
    s_waitcnt vmcnt(0)
    v_cmp_ne_u32 vcc, s3, v120
    s_cbranch_vccz L_adaLN_cond__grouped_kv_mqa__dense_activation_relu__prompt_kernel_fsd_3
    s_sleep 4
    s_sub_u32 s11, s11, 1
    s_cmp_lg_u32 s11, 0
    s_cbranch_scc1 L_adaLN_cond__grouped_kv_mqa__dense_activation_relu__prompt_kernel_fs_2
L_adaLN_cond__grouped_kv_mqa__dense_activation_relu__prompt_kernel_fsd_3:
    s_mov_b64 exec, -1
    s_mov_b32 s9, s6
    v_lshlrev_b32 v6, 5, v2
    s_mul_i32 s10, s23, 18432
    s_mul_i32 s11, s9, 6144
    s_add_u32 s10, s10, s11
    s_add_u32 s10, s10, 32768
    s_mov_b32 s40, 0xffff
    buffer_load_dwordx4 v[16:19], v6, s[12:15], s10 offen sc1
    buffer_load_dwordx2 v[20:21], v6, s[12:15], s10 offen offset:16 sc1
    s_add_u32 s10, s10, 2048
    buffer_load_dwordx4 v[24:27], v6, s[12:15], s10 offen sc1
    buffer_load_dwordx2 v[28:29], v6, s[12:15], s10 offen offset:16 sc1
    s_add_u32 s10, s10, 2048
    buffer_load_dwordx4 v[32:35], v6, s[12:15], s10 offen sc1
    buffer_load_dwordx2 v[36:37], v6, s[12:15], s10 offen offset:16 sc1
    s_waitcnt vmcnt(4)
    v_add_f32 v40, v16, v18
    v_add_f32 v41, v17, v19
    v_add_f32 v40, v40, v20
    v_add_f32 v41, v41, v21
    v_cvt_pk_bf16_f32 v96, v40, v40
    v_lshlrev_b32 v42, 16, v96
    v_sub_f32 v40, v40, v42
    v_cvt_pk_bf16_f32 v43, v40, v40
    v_lshlrev_b32 v42, 16, v43
    v_sub_f32 v40, v40, v42
    v_cvt_pk_bf16_f32 v44, v40, v40
    v_cvt_pk_bf16_f32 v99, v41, v41
    v_lshlrev_b32 v42, 16, v99
    v_sub_f32 v41, v41, v42
    v_cvt_pk_bf16_f32 v45, v41, v41
    v_lshlrev_b32 v42, 16, v45
    v_sub_f32 v41, v41, v42
    v_cvt_pk_bf16_f32 v46, v41, v41
    v_bfi_b32 v97, s40, v43, v96
    v_bfi_b32 v98, s40, v43, v44
    v_bfi_b32 v100, s40, v45, v99
    v_bfi_b32 v101, s40, v45, v46
    v_mov_b32 v102, 0
    v_mov_b32 v103, 0
    s_waitcnt vmcnt(2)
    v_add_f32 v40, v24, v26
    v_add_f32 v41, v25, v27
    v_add_f32 v40, v40, v28
    v_add_f32 v41, v41, v29
    v_cvt_pk_bf16_f32 v104, v40, v40
    v_lshlrev_b32 v42, 16, v104
    v_sub_f32 v40, v40, v42
    v_cvt_pk_bf16_f32 v43, v40, v40
    v_lshlrev_b32 v42, 16, v43
    v_sub_f32 v40, v40, v42
    v_cvt_pk_bf16_f32 v44, v40, v40
    v_cvt_pk_bf16_f32 v107, v41, v41
    v_lshlrev_b32 v42, 16, v107
    v_sub_f32 v41, v41, v42
    v_cvt_pk_bf16_f32 v45, v41, v41
    v_lshlrev_b32 v42, 16, v45
    v_sub_f32 v41, v41, v42
    v_cvt_pk_bf16_f32 v46, v41, v41
    v_bfi_b32 v105, s40, v43, v104
    v_bfi_b32 v106, s40, v43, v44
    v_bfi_b32 v108, s40, v45, v107
    v_bfi_b32 v109, s40, v45, v46
    v_mov_b32 v110, 0
    v_mov_b32 v111, 0
    s_waitcnt vmcnt(0)
    v_add_f32 v40, v32, v34
    v_add_f32 v41, v33, v35
    v_add_f32 v40, v40, v36
    v_add_f32 v41, v41, v37
    v_cvt_pk_bf16_f32 v112, v40, v40
    v_lshlrev_b32 v42, 16, v112
    v_sub_f32 v40, v40, v42
    v_cvt_pk_bf16_f32 v43, v40, v40
    v_lshlrev_b32 v42, 16, v43
    v_sub_f32 v40, v40, v42
    v_cvt_pk_bf16_f32 v44, v40, v40
    v_cvt_pk_bf16_f32 v115, v41, v41
    v_lshlrev_b32 v42, 16, v115
    v_sub_f32 v41, v41, v42
    v_cvt_pk_bf16_f32 v45, v41, v41
    v_lshlrev_b32 v42, 16, v45
    v_sub_f32 v41, v41, v42
    v_cvt_pk_bf16_f32 v46, v41, v41
    v_bfi_b32 v113, s40, v43, v112
    v_bfi_b32 v114, s40, v43, v44
    v_bfi_b32 v116, s40, v45, v115
    v_bfi_b32 v117, s40, v45, v46
    v_mov_b32 v118, 0
    v_mov_b32 v119, 0
    s_cmp_lg_u32 s2, 0
    s_cbranch_scc1 L_kb_noax
    s_cmp_lg_u32 s6, 2
    s_cbranch_scc1 L_kb_noax
    s_add_u32 s9, s33, 1
    v_mov_b32 v120, s9
    v_mov_b32 v121, 0
    s_mov_b32 s9, 262144
    s_mov_b64 exec, 1
    buffer_store_dword v120, v121, s[12:15], s9 offen sc1
    s_mov_b64 exec, -1
L_kb_noax:
    s_cmp_ge_u32 s6, 8
    s_cbranch_scc1 L_kb_b3
    v_lshlrev_b32 v5, 7, v2
    s_mov_b32 s10, 376832
    s_mov_b32 s11, 262144
L_adaLN_cond__grouped_kv_mqa__dense_activation_relu__prompt_kernel_f2b_4:
    buffer_load_dwordx4 v[120:123], v5, s[12:15], s10 offen sc1
    s_waitcnt vmcnt(0)
    v_xor_b32 v120, s3, v120
    v_xor_b32 v121, s3, v121
    v_xor_b32 v122, s3, v122
    v_xor_b32 v123, s3, v123
    v_or3_b32 v120, v120, v121, v122
    v_or_b32 v120, v120, v123
    v_cmp_ne_u32 vcc, 0, v120
    s_cbranch_vccz L_adaLN_cond__grouped_kv_mqa__dense_activation_relu__prompt_kernel_f2bd_5
    s_sleep 4
    s_sub_u32 s11, s11, 1
    s_cmp_lg_u32 s11, 0
    s_cbranch_scc1 L_adaLN_cond__grouped_kv_mqa__dense_activation_relu__prompt_kernel_f2b_4
L_adaLN_cond__grouped_kv_mqa__dense_activation_relu__prompt_kernel_f2bd_5:
L_kb_pref:
    s_mul_i32 s36, s21, 9
    s_add_u32 s36, s36, s6
    s_mul_i32 s10, s36, 18432
    s_add_u32 s10, s10, 2097152
    buffer_load_dwordx4 v[8:11], v1, s[12:15], s10 offen offset:0 sc1
    buffer_load_dwordx4 v[12:15], v1, s[12:15], s10 offen offset:1024 sc1
    buffer_load_dwordx4 v[16:19], v1, s[12:15], s10 offen offset:2048 sc1
    buffer_load_dwordx4 v[20:23], v1, s[12:15], s10 offen offset:3072 sc1
    s_add_u32 s10, s10, 4096
    buffer_load_dwordx4 v[24:27], v1, s[12:15], s10 offen offset:0 sc1
    buffer_load_dwordx4 v[28:31], v1, s[12:15], s10 offen offset:1024 sc1
    buffer_load_dwordx4 v[32:35], v1, s[12:15], s10 offen offset:2048 sc1
    buffer_load_dwordx4 v[36:39], v1, s[12:15], s10 offen offset:3072 sc1
    s_add_u32 s10, s10, 4096
    buffer_load_dwordx4 v[40:43], v1, s[12:15], s10 offen offset:0 sc1
    buffer_load_dwordx4 v[44:47], v1, s[12:15], s10 offen offset:1024 sc1
    buffer_load_dwordx4 v[48:51], v1, s[12:15], s10 offen offset:2048 sc1
    buffer_load_dwordx4 v[52:55], v1, s[12:15], s10 offen offset:3072 sc1
    s_add_u32 s10, s10, 4096
    buffer_load_dwordx4 v[56:59], v1, s[12:15], s10 offen offset:0 sc1
    buffer_load_dwordx4 v[60:63], v1, s[12:15], s10 offen offset:1024 sc1
    buffer_load_dwordx4 v[64:67], v1, s[12:15], s10 offen offset:2048 sc1
    buffer_load_dwordx4 v[68:71], v1, s[12:15], s10 offen offset:3072 sc1
    s_add_u32 s10, s10, 4096
    buffer_load_dwordx4 v[72:75], v1, s[12:15], s10 offen offset:0 sc1
    buffer_load_dwordx4 v[76:79], v1, s[12:15], s10 offen offset:1024 sc1
    s_mov_b32 s16, s28
    s_mov_b32 s17, s29
    s_mov_b32 s18, 2359296
    s_mov_b32 s19, 0x20000
    v_mul_u32_u24 v7, 1152, v3
    v_lshl_add_u32 v7, v4, 3, v7
    v_lshlrev_b32 v6, 4, v4
    s_mul_i32 s37, s20, 36864
    s_lshl_b32 s9, s36, 5
    s_add_u32 s37, s37, s9
    s_add_u32 s38, s37, 18432
    s_lshl_b32 s9, s36, 6
    s_add_u32 s10, s9, 4608
    s_add_u32 s9, s9, 9216
    buffer_load_dwordx2 v[80:81], v7, s[16:19], s37 offen
    buffer_load_dwordx2 v[82:83], v7, s[16:19], s38 offen
    buffer_load_dwordx4 v[84:87], v6, s[12:15], s10 offen sc1
    buffer_load_dwordx4 v[88:91], v6, s[12:15], s9 offen sc1
    s_cmp_eq_u32 s6, 8
    s_cbranch_scc1 L_kb_b4x
    s_mov_b32 s50, 4194304
    v_lshlrev_b32 v5, 7, v2
    s_cmp_lt_u32 s6, 3
    s_cbranch_scc1 L_kb_tch
    s_branch L_kb_b3
L_kb_tch:
    s_mul_i32 s10, s23, 663552
    s_mul_i32 s11, s55, 41472
    s_add_u32 s10, s10, s11
    s_mul_i32 s11, s7, 13824
    s_add_u32 s10, s10, s11
    s_add_u32 s10, s10, s50
    buffer_load_dword v126, v5, s[12:15], s10 offen
    s_add_u32 s10, s10, 6912
    buffer_load_dword v127, v5, s[12:15], s10 offen
L_kb_b3:
    s_setprio 0
    s_waitcnt lgkmcnt(0)
    s_barrier
    s_cmp_lt_u32 s8, 2
    s_cbranch_scc1 L_kb_b4
    s_sub_u32 s50, 3, s8
    s_mul_i32 s11, s7, 9472
    s_lshl_b32 s9, s50, 11
    s_add_u32 s9, s9, s11
    v_add_u32 v5, s9, v1
    s_lshl_b32 s9, s50, 10
    s_add_u32 s9, s9, s11
    v_add_u32 v6, s9, v1
    s_sub_u32 s9, s8, 2
    s_mul_i32 s9, s9, 37888
    s_add_u32 s9, s9, s11
    v_add_u32 v7, s9, v1
    ds_read_b128 v[8:11], v5 offset:0
    ds_read_b128 v[12:15], v5 offset:1024
    ds_read_b128 v[16:19], v6 offset:4096
    ds_read_b128 v[20:23], v5 offset:37888
    ds_read_b128 v[24:27], v5 offset:38912
    ds_read_b128 v[28:31], v6 offset:41984
    ds_read_b128 v[32:35], v7 offset:6144
    ds_read_b128 v[36:39], v7 offset:7168
    ds_read_b128 v[40:43], v7 offset:8192
    s_mul_i32 s9, s7, 36
    s_mul_i32 s10, s50, 18
    s_add_u32 s9, s9, s10
    v_lshlrev_b32 v6, 2, v4
    v_add_u32 v6, s9, v6
    v_lshlrev_b32 v7, 4, v3
    s_mul_i32 s9, s21, 9216
    s_add_u32 s9, s9, 113664
    v_add_u32 v7, s9, v7
    v_add_u32 v62, 0, v6
    v_lshrrev_b32 v63, 3, v62
    v_and_b32 v62, 7, v62
    v_lshl_add_u32 v63, v63, 9, v7
    v_lshl_add_u32 v64, v62, 1, v63
    v_add_u32 v62, 2, v6
    v_lshrrev_b32 v63, 3, v62
    v_and_b32 v62, 7, v62
    v_lshl_add_u32 v63, v63, 9, v7
    v_lshl_add_u32 v65, v62, 1, v63
    v_add_u32 v62, 8, v6
    v_lshrrev_b32 v63, 3, v62
    v_and_b32 v62, 7, v62
    v_lshl_add_u32 v63, v63, 9, v7
    v_lshl_add_u32 v66, v62, 1, v63
    v_add_u32 v62, 10, v6
    v_lshrrev_b32 v63, 3, v62
    v_and_b32 v62, 7, v62
    v_lshl_add_u32 v63, v63, 9, v7
    v_lshl_add_u32 v67, v62, 1, v63
    v_add_u32 v62, 16, v6
    v_lshrrev_b32 v63, 3, v62
    v_and_b32 v62, 7, v62
    v_lshl_add_u32 v63, v63, 9, v7
    v_lshl_add_u32 v68, v62, 1, v63
    s_waitcnt lgkmcnt(6)
    v_add_f32 v48, v48, v8
    v_add_f32 v49, v49, v9
    v_add_f32 v50, v50, v10
    v_add_f32 v51, v51, v11
    v_add_f32 v52, v52, v12
    v_add_f32 v53, v53, v13
    v_add_f32 v54, v54, v14
    v_add_f32 v55, v55, v15
    v_add_f32 v56, v56, v16
    v_add_f32 v57, v57, v17
    v_add_f32 v58, v58, v18
    s_waitcnt lgkmcnt(3)
    v_add_f32 v48, v48, v20
    v_add_f32 v49, v49, v21
    v_add_f32 v50, v50, v22
    v_add_f32 v51, v51, v23
    v_add_f32 v52, v52, v24
    v_add_f32 v53, v53, v25
    v_add_f32 v54, v54, v26
    v_add_f32 v55, v55, v27
    v_add_f32 v56, v56, v28
    v_add_f32 v57, v57, v29
    v_add_f32 v58, v58, v30
    s_waitcnt lgkmcnt(0)
    v_add_f32 v48, v48, v32
    v_add_f32 v49, v49, v33
    v_add_f32 v50, v50, v34
    v_add_f32 v51, v51, v35
    v_add_f32 v52, v52, v36
    v_add_f32 v53, v53, v37
    v_add_f32 v54, v54, v38
    v_add_f32 v55, v55, v39
    v_add_f32 v56, v56, v40
    v_add_f32 v57, v57, v41
    v_add_f32 v58, v58, v42
    v_mov_b32 v8, v58
    s_nop 1
    v_permlane32_swap_b32 v58, v8
    s_nop 1
    v_rcp_f32 v8, v58
    s_nop 0
    v_mul_f32 v48, v48, v8
    v_mul_f32 v49, v49, v8
    v_mul_f32 v50, v50, v8
    v_mul_f32 v51, v51, v8
    v_mul_f32 v52, v52, v8
    v_mul_f32 v53, v53, v8
    v_mul_f32 v54, v54, v8
    v_mul_f32 v55, v55, v8
    v_mul_f32 v56, v56, v8
    v_mul_f32 v57, v57, v8
    v_cvt_pk_bf16_f32 v80, v48, v49
    v_cvt_pk_bf16_f32 v81, v50, v51
    v_cvt_pk_bf16_f32 v82, v52, v53
    v_cvt_pk_bf16_f32 v83, v54, v55
    v_cvt_pk_bf16_f32 v84, v56, v57
    ds_write_b32 v64, v80
    ds_write_b32 v65, v81
    ds_write_b32 v66, v82
    ds_write_b32 v67, v83
    s_mov_b32 exec_hi, 0
    ds_write_b32 v68, v84
    s_mov_b64 exec, -1
    v_and_b32 v3, 15, v2
    v_lshrrev_b32 v4, 4, v2
    s_waitcnt lgkmcnt(0)
    s_cmp_lg_u32 s6, 8
    s_cbranch_scc1 L_kb_b4
    s_barrier
    s_branch L_kb_pref
L_kb_b4:
    s_barrier
L_kb_b4x:
    s_cmp_lt_u32 s6, 9
    s_cbranch_scc1 L_kb_nost9
    s_sub_u32 s9, s6, 9
    s_lshl_b32 s9, s9, 10
    s_mul_i32 s11, s21, 9216
    s_add_u32 s9, s9, s11
    s_add_u32 s10, s9, 113664
    v_add_u32 v5, s10, v1
    ds_read_b128 v[8:11], v5
    ds_read_b128 v[12:15], v5 offset:7168
    s_mul_i32 s10, s20, 36864
    s_add_u32 s10, s10, s9
    s_add_u32 s10, s10, 24117248
    s_add_u32 s11, s10, 7168
    s_waitcnt lgkmcnt(0)
    buffer_store_dwordx4 v[8:11], v1, s[12:15], s10 offen sc1
    s_cmp_ge_u32 s6, 11
    s_cbranch_scc1 L_kb_nost9
    buffer_store_dwordx4 v[12:15], v1, s[12:15], s11 offen sc1
L_kb_nost9:
    s_cmp_ge_u32 s6, 3
    s_cbranch_scc1 L_kb_noaxw
    v_lshlrev_b32 v5, 9, v4
    v_lshl_add_u32 v5, v3, 4, v5
    s_mul_i32 s11, s6, 6144
    s_add_u32 s11, s11, 77824
    v_add_u32 v5, s11, v5
    ds_write_b128 v5, v[96:99]
    ds_write_b128 v5, v[100:103] offset:256
    ds_write_b128 v5, v[104:107] offset:2048
    ds_write_b128 v5, v[108:111] offset:2304
    ds_write_b128 v5, v[112:115] offset:4096
    ds_write_b128 v5, v[116:119] offset:4352
    v_mov_b32 v5, 96256
    v_mov_b32 v92, 0
    v_mov_b32 v93, 0
    v_mov_b32 v94, 0
    v_mov_b32 v95, 0
    ds_write_b128 v5, v[92:95]
    ds_write_b128 v5, v[92:95] offset:512
    ds_write_b128 v5, v[92:95] offset:1024
L_kb_noaxw:
    s_add_u32 s9, s21, 1
    s_mul_i32 s9, s9, 9216
    s_lshl_b32 s10, s6, 10
    s_add_u32 s10, s10, s9
    s_add_u32 s50, s6, 16
    s_min_u32 s50, s50, 26
    s_lshl_b32 s50, s50, 10
    s_add_u32 s50, s50, s9
    s_sub_u32 s9, s10, 36864
    s_cmp_ge_u32 s10, 36864
    s_cselect_b32 s10, s9, s10
    s_sub_u32 s9, s50, 36864
    s_cmp_ge_u32 s50, 36864
    s_cselect_b32 s50, s9, s50
    s_mul_i32 s9, s20, 36864
    s_add_u32 s9, s9, 24117248
    s_add_u32 s51, s10, s9
    s_add_u32 s52, s50, s9
    s_add_u32 s10, s10, 113664
    s_add_u32 s50, s50, 113664
    v_add_u32 v5, s10, v1
    v_add_u32 v0, s50, v1
    s_mov_b32 s11, 262144
    s_cmp_lt_u32 s6, 9
    s_cbranch_scc1 L_kb_ob
    s_waitcnt vmcnt(0)
L_kb_ob:
    s_barrier
    s_sleep 6
L_kb_opoll:
    buffer_load_dwordx4 v[120:123], v1, s[12:15], s51 offen sc1
    buffer_load_dwordx4 v[124:127], v1, s[12:15], s52 offen sc1
    s_waitcnt vmcnt(0)
    v_max_u32 v6, v120, v121
    v_max3_u32 v6, v6, v122, v123
    v_max3_u32 v6, v6, v124, v125
    v_max3_u32 v6, v6, v126, v127
    v_cmp_eq_u32 vcc, -1, v6
    s_cbranch_vccz L_kb_ook
    s_sub_u32 s11, s11, 1
    s_cmp_lg_u32 s11, 0
    s_cbranch_scc1 L_kb_opoll
L_kb_ook:
    ds_write_b128 v5, v[120:123]
    ds_write_b128 v0, v[124:127]
    s_waitcnt lgkmcnt(0)
    s_barrier
    s_mul_i32 s40, s23, 36
    s_mul_i32 s43, s6, 3
    s_add_u32 s40, s40, s43
    s_mul_i32 s40, s40, 18432
    s_add_u32 s44, s40, 10485760
    s_add_u32 s40, s40, 4194304
    s_add_u32 s41, s40, 18432
    s_add_u32 s42, s40, 36864
    s_add_u32 s45, s44, 18432
    s_add_u32 s46, s44, 36864
    s_mul_i32 s48, s23, 36
    s_add_u32 s48, s48, s43
    s_lshl_b32 s48, s48, 10
    s_add_u32 s48, s48, 3145728
    s_cmp_lt_u32 s6, 9
    s_cbranch_scc1 L_kb_op
    s_cmp_ge_u32 s6, 12
    s_cbranch_scc1 L_kb_h1
    buffer_load_dwordx4 v[52:55], v1, s[12:15], s40 offen offset:0 sc1
    buffer_load_dwordx4 v[56:59], v1, s[12:15], s41 offen offset:0 sc1
    buffer_load_dwordx4 v[60:63], v1, s[12:15], s42 offen offset:0 sc1
    buffer_load_dwordx4 v[64:67], v1, s[12:15], s40 offen offset:1024 sc1
    buffer_load_dwordx4 v[68:71], v1, s[12:15], s41 offen offset:1024 sc1
    buffer_load_dwordx4 v[72:75], v1, s[12:15], s42 offen offset:1024 sc1
    buffer_load_dwordx4 v[76:79], v1, s[12:15], s40 offen offset:2048 sc1
    buffer_load_dwordx4 v[80:83], v1, s[12:15], s41 offen offset:2048 sc1
    buffer_load_dwordx4 v[84:87], v1, s[12:15], s42 offen offset:2048 sc1
    buffer_load_dwordx4 v[88:91], v1, s[12:15], s40 offen offset:3072 sc1
    buffer_load_dwordx4 v[92:95], v1, s[12:15], s41 offen offset:3072 sc1
    buffer_load_dwordx4 v[96:99], v1, s[12:15], s42 offen offset:3072 sc1
    s_add_u32 s40, s40, 4096
    buffer_load_dwordx4 v[100:103], v1, s[12:15], s40 offen offset:0 sc1
    s_add_u32 s41, s41, 4096
    buffer_load_dwordx4 v[104:107], v1, s[12:15], s41 offen offset:0 sc1
    s_add_u32 s42, s42, 4096
    buffer_load_dwordx4 v[108:111], v1, s[12:15], s42 offen offset:0 sc1
    s_branch L_kb_ffn
L_kb_op:
    v_lshlrev_b32 v5, 9, v4
    v_lshl_add_u32 v5, v3, 4, v5
    v_add_u32 v5, 113664, v5
    ds_read_b128 v[92:95], v5 offset:0
    ds_read_b128 v[96:99], v5 offset:256
    ds_read_b128 v[100:103], v5 offset:2048
    ds_read_b128 v[104:107], v5 offset:2304
    s_waitcnt vmcnt(0)
    ds_read_b128 v[108:111], v5 offset:4096
    ds_read_b128 v[112:115], v5 offset:4352
    s_waitcnt lgkmcnt(4)
    v_mfma_f32_16x16x32_bf16 v[116:119], v[8:11], v[92:95], 0
    v_mfma_f32_16x16x32_bf16 v[120:123], v[8:11], v[96:99], 0
    ds_read_b128 v[92:95], v5 offset:6144
    ds_read_b128 v[96:99], v5 offset:6400
    s_waitcnt lgkmcnt(4)
    v_mfma_f32_16x16x32_bf16 v[116:119], v[12:15], v[100:103], v[116:119]
    v_mfma_f32_16x16x32_bf16 v[120:123], v[12:15], v[104:107], v[120:123]
    ds_read_b128 v[100:103], v5 offset:8192
    ds_read_b128 v[104:107], v5 offset:8448
    s_waitcnt lgkmcnt(4)
    v_mfma_f32_16x16x32_bf16 v[116:119], v[16:19], v[108:111], v[116:119]
    v_mfma_f32_16x16x32_bf16 v[120:123], v[16:19], v[112:115], v[120:123]
    ds_read_b128 v[108:111], v5 offset:10240
    ds_read_b128 v[112:115], v5 offset:10496
    s_waitcnt lgkmcnt(4)
    v_mfma_f32_16x16x32_bf16 v[116:119], v[20:23], v[92:95], v[116:119]
    v_mfma_f32_16x16x32_bf16 v[120:123], v[20:23], v[96:99], v[120:123]
    ds_read_b128 v[92:95], v5 offset:12288
    ds_read_b128 v[96:99], v5 offset:12544
    s_waitcnt lgkmcnt(4)
    v_mfma_f32_16x16x32_bf16 v[116:119], v[24:27], v[100:103], v[116:119]
    v_mfma_f32_16x16x32_bf16 v[120:123], v[24:27], v[104:107], v[120:123]
    ds_read_b128 v[100:103], v5 offset:14336
    ds_read_b128 v[104:107], v5 offset:14592
    s_waitcnt lgkmcnt(4)
    v_mfma_f32_16x16x32_bf16 v[116:119], v[28:31], v[108:111], v[116:119]
    v_mfma_f32_16x16x32_bf16 v[120:123], v[28:31], v[112:115], v[120:123]
    ds_read_b128 v[108:111], v5 offset:16384
    ds_read_b128 v[112:115], v5 offset:16640
    s_waitcnt lgkmcnt(4)
    v_mfma_f32_16x16x32_bf16 v[116:119], v[32:35], v[92:95], v[116:119]
    v_mfma_f32_16x16x32_bf16 v[120:123], v[32:35], v[96:99], v[120:123]
    ds_read_b128 v[92:95], v5 offset:18432
    ds_read_b128 v[96:99], v5 offset:18688
    s_waitcnt lgkmcnt(4)
    v_mfma_f32_16x16x32_bf16 v[116:119], v[36:39], v[100:103], v[116:119]
    v_mfma_f32_16x16x32_bf16 v[120:123], v[36:39], v[104:107], v[120:123]
    ds_read_b128 v[100:103], v5 offset:20480
    ds_read_b128 v[104:107], v5 offset:20736
    s_waitcnt lgkmcnt(4)
    v_mfma_f32_16x16x32_bf16 v[116:119], v[40:43], v[108:111], v[116:119]
    v_mfma_f32_16x16x32_bf16 v[120:123], v[40:43], v[112:115], v[120:123]
    ds_read_b128 v[108:111], v5 offset:22528
    ds_read_b128 v[112:115], v5 offset:22784
    s_waitcnt lgkmcnt(4)
    v_mfma_f32_16x16x32_bf16 v[116:119], v[44:47], v[92:95], v[116:119]
    v_mfma_f32_16x16x32_bf16 v[120:123], v[44:47], v[96:99], v[120:123]
    ds_read_b128 v[92:95], v5 offset:24576
    ds_read_b128 v[96:99], v5 offset:24832
    s_waitcnt lgkmcnt(4)
    v_mfma_f32_16x16x32_bf16 v[116:119], v[48:51], v[100:103], v[116:119]
    v_mfma_f32_16x16x32_bf16 v[120:123], v[48:51], v[104:107], v[120:123]
    ds_read_b128 v[100:103], v5 offset:26624
    ds_read_b128 v[104:107], v5 offset:26880
    s_waitcnt lgkmcnt(4)
    v_mfma_f32_16x16x32_bf16 v[116:119], v[52:55], v[108:111], v[116:119]
    v_mfma_f32_16x16x32_bf16 v[120:123], v[52:55], v[112:115], v[120:123]
    ds_read_b128 v[108:111], v5 offset:28672
    ds_read_b128 v[112:115], v5 offset:28928
    s_waitcnt lgkmcnt(4)
    v_mfma_f32_16x16x32_bf16 v[116:119], v[56:59], v[92:95], v[116:119]
    v_mfma_f32_16x16x32_bf16 v[120:123], v[56:59], v[96:99], v[120:123]
    ds_read_b128 v[92:95], v5 offset:30720
    ds_read_b128 v[96:99], v5 offset:30976
    s_waitcnt lgkmcnt(4)
    v_mfma_f32_16x16x32_bf16 v[116:119], v[60:63], v[100:103], v[116:119]
    v_mfma_f32_16x16x32_bf16 v[120:123], v[60:63], v[104:107], v[120:123]
    ds_read_b128 v[100:103], v5 offset:32768
    ds_read_b128 v[104:107], v5 offset:33024
    s_waitcnt lgkmcnt(4)
    v_mfma_f32_16x16x32_bf16 v[116:119], v[64:67], v[108:111], v[116:119]
    v_mfma_f32_16x16x32_bf16 v[120:123], v[64:67], v[112:115], v[120:123]
    ds_read_b128 v[108:111], v5 offset:34816
    ds_read_b128 v[112:115], v5 offset:35072
    s_waitcnt lgkmcnt(4)
    v_mfma_f32_16x16x32_bf16 v[116:119], v[68:71], v[92:95], v[116:119]
    v_mfma_f32_16x16x32_bf16 v[120:123], v[68:71], v[96:99], v[120:123]
    s_waitcnt lgkmcnt(2)
    v_mfma_f32_16x16x32_bf16 v[116:119], v[72:75], v[100:103], v[116:119]
    v_mfma_f32_16x16x32_bf16 v[120:123], v[72:75], v[104:107], v[120:123]
    s_waitcnt lgkmcnt(0)
    v_mfma_f32_16x16x32_bf16 v[116:119], v[76:79], v[108:111], v[116:119]
    v_mfma_f32_16x16x32_bf16 v[120:123], v[76:79], v[112:115], v[120:123]
    v_mov_b32 v8, v80
    v_mov_b32 v9, v81
    v_mov_b32 v10, v82
    v_mov_b32 v11, v83
    v_mov_b32 v12, v84
    v_mov_b32 v13, v85
    v_mov_b32 v14, v86
    v_mov_b32 v15, v87
    v_mov_b32 v16, v88
    v_mov_b32 v17, v89
    v_mov_b32 v18, v90
    v_mov_b32 v19, v91
    buffer_load_dwordx4 v[52:55], v1, s[12:15], s40 offen offset:0 sc1
    buffer_load_dwordx4 v[56:59], v1, s[12:15], s41 offen offset:0 sc1
    buffer_load_dwordx4 v[60:63], v1, s[12:15], s42 offen offset:0 sc1
    buffer_load_dwordx4 v[64:67], v1, s[12:15], s40 offen offset:1024 sc1
    buffer_load_dwordx4 v[68:71], v1, s[12:15], s41 offen offset:1024 sc1
    buffer_load_dwordx4 v[72:75], v1, s[12:15], s42 offen offset:1024 sc1
    buffer_load_dwordx4 v[76:79], v1, s[12:15], s40 offen offset:2048 sc1
    buffer_load_dwordx4 v[80:83], v1, s[12:15], s41 offen offset:2048 sc1
    buffer_load_dwordx4 v[84:87], v1, s[12:15], s42 offen offset:2048 sc1
    v_cvt_pk_bf16_f32 v24, v116, v117
    v_cvt_pk_bf16_f32 v25, v118, v119
    v_cvt_pk_bf16_f32 v26, v120, v121
    v_cvt_pk_bf16_f32 v27, v122, v123
    v_lshlrev_b32 v116, 16, v24
    v_and_b32 v117, 0xffff0000, v24
    v_lshlrev_b32 v118, 16, v25
    v_and_b32 v119, 0xffff0000, v25
    v_lshlrev_b32 v120, 16, v26
    v_and_b32 v121, 0xffff0000, v26
    v_lshlrev_b32 v122, 16, v27
    v_and_b32 v123, 0xffff0000, v27
    v_mul_f32 v116, v116, v12
    v_mul_f32 v117, v117, v13
    v_mul_f32 v118, v118, v14
    v_mul_f32 v119, v119, v15
    v_mul_f32 v120, v120, v12
    v_mul_f32 v121, v121, v13
    v_mul_f32 v122, v122, v14
    v_mul_f32 v123, v123, v15
    v_cvt_pk_bf16_f32 v24, v116, v117
    v_cvt_pk_bf16_f32 v25, v118, v119
    v_cvt_pk_bf16_f32 v26, v120, v121
    v_cvt_pk_bf16_f32 v27, v122, v123
    v_lshlrev_b32 v116, 16, v24
    v_and_b32 v117, 0xffff0000, v24
    v_lshlrev_b32 v32, 16, v8
    v_and_b32 v33, 0xffff0000, v8
    v_lshlrev_b32 v118, 16, v25
    v_and_b32 v119, 0xffff0000, v25
    v_lshlrev_b32 v34, 16, v9
    v_and_b32 v35, 0xffff0000, v9
    v_lshlrev_b32 v120, 16, v26
    v_and_b32 v121, 0xffff0000, v26
    v_lshlrev_b32 v36, 16, v10
    v_and_b32 v37, 0xffff0000, v10
    v_lshlrev_b32 v122, 16, v27
    v_and_b32 v123, 0xffff0000, v27
    v_lshlrev_b32 v38, 16, v11
    v_and_b32 v39, 0xffff0000, v11
    v_add_f32 v116, v116, v32
    v_add_f32 v117, v117, v33
    v_add_f32 v118, v118, v34
    v_add_f32 v119, v119, v35
    v_add_f32 v120, v120, v36
    v_add_f32 v121, v121, v37
    v_add_f32 v122, v122, v38
    v_add_f32 v123, v123, v39
    v_cvt_pk_bf16_f32 v24, v116, v117
    v_cvt_pk_bf16_f32 v25, v118, v119
    v_cvt_pk_bf16_f32 v26, v120, v121
    v_cvt_pk_bf16_f32 v27, v122, v123
    s_lshl_b32 s9, s6, 10
    s_add_u32 s10, s9, 151552
    v_add_u32 v5, s10, v1
    ds_write_b128 v5, v[24:27]
    v_lshlrev_b32 v116, 16, v24
    v_and_b32 v117, 0xffff0000, v24
    v_lshlrev_b32 v118, 16, v25
    v_and_b32 v119, 0xffff0000, v25
    v_lshlrev_b32 v120, 16, v26
    v_and_b32 v121, 0xffff0000, v26
    v_lshlrev_b32 v122, 16, v27
    v_and_b32 v123, 0xffff0000, v27
    v_mul_f32 v32, v116, v16
    v_mul_f32 v33, v117, v17
    v_mul_f32 v34, v118, v18
    v_mul_f32 v35, v119, v19
    v_mul_f32 v36, v120, v16
    v_mul_f32 v37, v121, v17
    v_mul_f32 v38, v122, v18
    v_mul_f32 v39, v123, v19
    v_cvt_pk_bf16_f32 v28, v32, v33
    v_cvt_pk_bf16_f32 v29, v34, v35
    v_cvt_pk_bf16_f32 v30, v36, v37
    v_cvt_pk_bf16_f32 v31, v38, v39
    s_mul_i32 s10, s20, 36864
    s_mul_i32 s11, s21, 9216
    s_add_u32 s10, s10, s11
    s_add_u32 s10, s10, s9
    s_add_u32 s10, s10, 30408704
    v_permlane16_swap_b32 v28, v30
    v_permlane16_swap_b32 v29, v31
    s_nop 1
    buffer_store_dwordx4 v[28:31], v1, s[12:15], s10 offen sc1
    s_cmp_lg_u32 s6, 8
    s_cbranch_scc1 L_kb_nyf
    v_mov_b32 v40, 163360
    v_mov_b32 v41, s3
    ds_write_b32 v40, v41
L_kb_nyf:
    v_add_f32 v40, v116, v117
    v_add_f32 v41, v120, v121
    v_add_f32 v42, v118, v119
    v_add_f32 v43, v122, v123
    v_add_f32 v40, v40, v42
    v_add_f32 v41, v41, v43
    v_mov_b32 v42, v40
    v_mov_b32 v43, v41
    s_nop 1
    v_permlane16_swap_b32 v40, v42
    v_permlane16_swap_b32 v41, v43
    s_nop 1
    v_add_f32 v40, v40, v42
    v_add_f32 v41, v41, v43
    v_mov_b32 v42, v40
    v_mov_b32 v43, v41
    s_nop 1
    v_permlane32_swap_b32 v40, v42
    v_permlane32_swap_b32 v41, v43
    s_nop 1
    v_add_f32 v40, v40, v42
    v_add_f32 v41, v41, v43
    v_mul_f32 v40, 0x3d800000, v40
    v_mul_f32 v41, 0x3d800000, v41
    v_sub_f32 v116, v116, v40
    v_sub_f32 v117, v117, v40
    v_sub_f32 v118, v118, v40
    v_sub_f32 v119, v119, v40
    v_sub_f32 v120, v120, v41
    v_sub_f32 v121, v121, v41
    v_sub_f32 v122, v122, v41
    v_sub_f32 v123, v123, v41
    v_mul_f32 v44, v116, v116
    v_mul_f32 v46, v120, v120
    v_fmac_f32 v44, v117, v117
    v_fmac_f32 v46, v121, v121
    v_fmac_f32 v44, v118, v118
    v_fmac_f32 v46, v122, v122
    v_fmac_f32 v44, v119, v119
    v_fmac_f32 v46, v123, v123
    v_mov_b32 v42, v44
    v_mov_b32 v43, v46
    s_nop 1
    v_permlane16_swap_b32 v44, v42
    v_permlane16_swap_b32 v46, v43
    s_nop 1
    v_add_f32 v44, v44, v42
    v_add_f32 v46, v46, v43
    v_mov_b32 v42, v44
    v_mov_b32 v43, v46
    s_nop 1
    v_permlane32_swap_b32 v44, v42
    v_permlane32_swap_b32 v46, v43
    s_nop 1
    v_add_f32 v44, v44, v42
    v_add_f32 v46, v46, v43
    v_mov_b32 v45, v44
    v_mov_b32 v44, v40
    v_mov_b32 v47, v46
    v_mov_b32 v46, v41
    s_lshl_b32 s9, s6, 8
    s_add_u32 s9, s9, 161024
    v_lshlrev_b32 v42, 3, v3
    v_add_u32 v42, s9, v42
    ds_write_b64 v42, v[44:45]
    ds_write_b64 v42, v[46:47] offset:128
    s_waitcnt lgkmcnt(0)
    s_branch L_kb_ffn
L_kb_h1:
    v_mov_b32 v8, 163360
    s_mov_b32 s11, 262144
L_kb_ys:
    ds_read_b32 v9, v8
    s_waitcnt lgkmcnt(0)
    v_readfirstlane_b32 s9, v9
    s_cmp_eq_u32 s9, s3
    s_cbranch_scc1 L_kb_ysk
    s_sleep 1
    s_sub_u32 s11, s11, 1
    s_cmp_lg_u32 s11, 0
    s_cbranch_scc1 L_kb_ys
L_kb_ysk:
    s_sleep 4
    s_lshr_b32 s36, s7, 1
    s_and_b32 s37, s7, 1
    s_mul_i32 s37, s37, 3072
    s_mul_i32 s9, s36, 38912
    s_add_u32 s9, s9, s37
    v_add_u32 v5, s9, v1
    s_lshl_b32 s10, s22, 1
    s_add_u32 s10, s10, s36
    s_mul_i32 s10, s10, 36864
    s_add_u32 s10, s10, s37
    s_add_u32 s10, s10, 30408704
    s_mov_b32 s11, 262144
L_kb_yp0:
    s_add_u32 s9, s10, 0
    buffer_load_dwordx4 v[8:11], v1, s[12:15], s9 offen offset:0 sc1
    buffer_load_dwordx4 v[12:15], v1, s[12:15], s9 offen offset:1024 sc1
    buffer_load_dwordx4 v[16:19], v1, s[12:15], s9 offen offset:2048 sc1
    s_waitcnt vmcnt(0)
L_kb_yc0:
    v_max_u32 v6, v8, v9
    v_max3_u32 v6, v6, v10, v11
    v_max3_u32 v6, v6, v12, v13
    v_max3_u32 v6, v6, v14, v15
    v_max3_u32 v6, v6, v16, v17
    v_max3_u32 v6, v6, v18, v19
    v_cmp_eq_u32 vcc, -1, v6
    s_cbranch_vccz L_kb_yk0
    s_sub_u32 s11, s11, 1
    s_cmp_lg_u32 s11, 0
    s_cbranch_scc1 L_kb_yp0
L_kb_yk0:
    s_add_u32 s9, s10, 6144
    buffer_load_dwordx4 v[20:23], v1, s[12:15], s9 offen offset:0 sc1
    buffer_load_dwordx4 v[24:27], v1, s[12:15], s9 offen offset:1024 sc1
    buffer_load_dwordx4 v[28:31], v1, s[12:15], s9 offen offset:2048 sc1
    s_add_u32 s9, s10, 12288
    buffer_load_dwordx4 v[32:35], v1, s[12:15], s9 offen offset:0 sc1
    buffer_load_dwordx4 v[36:39], v1, s[12:15], s9 offen offset:1024 sc1
    buffer_load_dwordx4 v[40:43], v1, s[12:15], s9 offen offset:2048 sc1
    s_add_u32 s9, s10, 18432
    buffer_load_dwordx4 v[44:47], v1, s[12:15], s9 offen offset:0 sc1
    buffer_load_dwordx4 v[48:51], v1, s[12:15], s9 offen offset:1024 sc1
    buffer_load_dwordx4 v[52:55], v1, s[12:15], s9 offen offset:2048 sc1
    s_add_u32 s9, s10, 24576
    buffer_load_dwordx4 v[56:59], v1, s[12:15], s9 offen offset:0 sc1
    buffer_load_dwordx4 v[60:63], v1, s[12:15], s9 offen offset:1024 sc1
    buffer_load_dwordx4 v[64:67], v1, s[12:15], s9 offen offset:2048 sc1
    s_add_u32 s9, s10, 30720
    buffer_load_dwordx4 v[68:71], v1, s[12:15], s9 offen offset:0 sc1
    buffer_load_dwordx4 v[72:75], v1, s[12:15], s9 offen offset:1024 sc1
    buffer_load_dwordx4 v[76:79], v1, s[12:15], s9 offen offset:2048 sc1
    ds_write_b128 v5, v[8:11] offset:0
    ds_write_b128 v5, v[12:15] offset:1024
    ds_write_b128 v5, v[16:19] offset:2048
    s_waitcnt lgkmcnt(0)
    s_barrier
    s_cmp_lg_u32 s6, 15
    s_cbranch_scc1 L_kb_nost
    v_and_b32 v90, 31, v2
    v_lshlrev_b32 v90, 3, v90
    v_add_u32 v91, 161024, v90
    ds_read_b64 v[96:97], v91 offset:0
    ds_read_b64 v[98:99], v91 offset:256
    ds_read_b64 v[100:101], v91 offset:512
    ds_read_b64 v[102:103], v91 offset:768
    ds_read_b64 v[104:105], v91 offset:1024
    ds_read_b64 v[106:107], v91 offset:1280
    ds_read_b64 v[108:109], v91 offset:1536
    ds_read_b64 v[110:111], v91 offset:1792
    ds_read_b64 v[112:113], v91 offset:2048
    s_waitcnt lgkmcnt(0)
    v_add_f32 v92, v96, v98
    v_add_f32 v92, v92, v100
    v_add_f32 v92, v92, v102
    v_add_f32 v92, v92, v104
    v_add_f32 v92, v92, v106
    v_add_f32 v92, v92, v108
    v_add_f32 v92, v92, v110
    v_add_f32 v92, v92, v112
    v_mul_f32 v92, 0x3de38e39, v92
    v_add_f32 v93, v97, v99
    v_add_f32 v93, v93, v101
    v_add_f32 v93, v93, v103
    v_add_f32 v93, v93, v105
    v_add_f32 v93, v93, v107
    v_add_f32 v93, v93, v109
    v_add_f32 v93, v93, v111
    v_add_f32 v93, v93, v113
    v_mov_b32 v94, 0
    v_sub_f32 v95, v96, v92
    v_fmac_f32 v94, v95, v95
    v_sub_f32 v95, v98, v92
    v_fmac_f32 v94, v95, v95
    v_sub_f32 v95, v100, v92
    v_fmac_f32 v94, v95, v95
    v_sub_f32 v95, v102, v92
    v_fmac_f32 v94, v95, v95
    v_sub_f32 v95, v104, v92
    v_fmac_f32 v94, v95, v95
    v_sub_f32 v95, v106, v92
    v_fmac_f32 v94, v95, v95
    v_sub_f32 v95, v108, v92
    v_fmac_f32 v94, v95, v95
    v_sub_f32 v95, v110, v92
    v_fmac_f32 v94, v95, v95
    v_sub_f32 v95, v112, v92
    v_fmac_f32 v94, v95, v95
    v_fmac_f32 v93, 0x41800000, v94
    v_lshlrev_b32 v90, 2, v90
    s_lshl_b32 s9, s20, 10
    s_lshl_b32 s39, s21, 3
    s_add_u32 s9, s9, s39
    s_add_u32 s9, s9, 196608
    s_mov_b32 exec_hi, 0
    buffer_store_dwordx2 v[92:93], v90, s[12:15], s9 offen sc1
    s_mov_b64 exec, -1
L_kb_nost:
    s_mov_b32 s11, 262144
    s_waitcnt vmcnt(12)
    s_branch L_kb_yc1
L_kb_yp1:
    s_add_u32 s9, s10, 6144
    buffer_load_dwordx4 v[20:23], v1, s[12:15], s9 offen offset:0 sc1
    buffer_load_dwordx4 v[24:27], v1, s[12:15], s9 offen offset:1024 sc1
    buffer_load_dwordx4 v[28:31], v1, s[12:15], s9 offen offset:2048 sc1
    s_waitcnt vmcnt(0)
L_kb_yc1:
    v_max_u32 v6, v20, v21
    v_max3_u32 v6, v6, v22, v23
    v_max3_u32 v6, v6, v24, v25
    v_max3_u32 v6, v6, v26, v27
    v_max3_u32 v6, v6, v28, v29
    v_max3_u32 v6, v6, v30, v31
    v_cmp_eq_u32 vcc, -1, v6
    s_cbranch_vccz L_kb_yk1
    s_sub_u32 s11, s11, 1
    s_cmp_lg_u32 s11, 0
    s_cbranch_scc1 L_kb_yp1
L_kb_yk1:
    ds_write_b128 v5, v[20:23] offset:6144
    ds_write_b128 v5, v[24:27] offset:7168
    ds_write_b128 v5, v[28:31] offset:8192
    s_waitcnt lgkmcnt(0)
    s_barrier
    s_mov_b32 s11, 262144
    s_waitcnt vmcnt(9)
    s_branch L_kb_yc2
L_kb_yp2:
    s_add_u32 s9, s10, 12288
    buffer_load_dwordx4 v[32:35], v1, s[12:15], s9 offen offset:0 sc1
    buffer_load_dwordx4 v[36:39], v1, s[12:15], s9 offen offset:1024 sc1
    buffer_load_dwordx4 v[40:43], v1, s[12:15], s9 offen offset:2048 sc1
    s_waitcnt vmcnt(0)
L_kb_yc2:
    v_max_u32 v6, v32, v33
    v_max3_u32 v6, v6, v34, v35
    v_max3_u32 v6, v6, v36, v37
    v_max3_u32 v6, v6, v38, v39
    v_max3_u32 v6, v6, v40, v41
    v_max3_u32 v6, v6, v42, v43
    v_cmp_eq_u32 vcc, -1, v6
    s_cbranch_vccz L_kb_yk2
    s_sub_u32 s11, s11, 1
    s_cmp_lg_u32 s11, 0
    s_cbranch_scc1 L_kb_yp2
L_kb_yk2:
    ds_write_b128 v5, v[32:35] offset:12288
    ds_write_b128 v5, v[36:39] offset:13312
    ds_write_b128 v5, v[40:43] offset:14336
    s_mov_b32 s11, 262144
    s_waitcnt vmcnt(6)
    s_branch L_kb_yc3
L_kb_yp3:
    s_add_u32 s9, s10, 18432
    buffer_load_dwordx4 v[44:47], v1, s[12:15], s9 offen offset:0 sc1
    buffer_load_dwordx4 v[48:51], v1, s[12:15], s9 offen offset:1024 sc1
    buffer_load_dwordx4 v[52:55], v1, s[12:15], s9 offen offset:2048 sc1
    s_waitcnt vmcnt(0)
L_kb_yc3:
    v_max_u32 v6, v44, v45
    v_max3_u32 v6, v6, v46, v47
    v_max3_u32 v6, v6, v48, v49
    v_max3_u32 v6, v6, v50, v51
    v_max3_u32 v6, v6, v52, v53
    v_max3_u32 v6, v6, v54, v55
    v_cmp_eq_u32 vcc, -1, v6
    s_cbranch_vccz L_kb_yk3
    s_sub_u32 s11, s11, 1
    s_cmp_lg_u32 s11, 0
    s_cbranch_scc1 L_kb_yp3
L_kb_yk3:
    ds_write_b128 v5, v[44:47] offset:18432
    ds_write_b128 v5, v[48:51] offset:19456
    ds_write_b128 v5, v[52:55] offset:20480
    s_mov_b32 s11, 262144
    s_waitcnt vmcnt(3)
    s_branch L_kb_yc4
L_kb_yp4:
    s_add_u32 s9, s10, 24576
    buffer_load_dwordx4 v[56:59], v1, s[12:15], s9 offen offset:0 sc1
    buffer_load_dwordx4 v[60:63], v1, s[12:15], s9 offen offset:1024 sc1
    buffer_load_dwordx4 v[64:67], v1, s[12:15], s9 offen offset:2048 sc1
    s_waitcnt vmcnt(0)
L_kb_yc4:
    v_max_u32 v6, v56, v57
    v_max3_u32 v6, v6, v58, v59
    v_max3_u32 v6, v6, v60, v61
    v_max3_u32 v6, v6, v62, v63
    v_max3_u32 v6, v6, v64, v65
    v_max3_u32 v6, v6, v66, v67
    v_cmp_eq_u32 vcc, -1, v6
    s_cbranch_vccz L_kb_yk4
    s_sub_u32 s11, s11, 1
    s_cmp_lg_u32 s11, 0
    s_cbranch_scc1 L_kb_yp4
L_kb_yk4:
    ds_write_b128 v5, v[56:59] offset:24576
    ds_write_b128 v5, v[60:63] offset:25600
    ds_write_b128 v5, v[64:67] offset:26624
    s_mov_b32 s11, 262144
    s_waitcnt vmcnt(0)
    s_branch L_kb_yc5
L_kb_yp5:
    s_add_u32 s9, s10, 30720
    buffer_load_dwordx4 v[68:71], v1, s[12:15], s9 offen offset:0 sc1
    buffer_load_dwordx4 v[72:75], v1, s[12:15], s9 offen offset:1024 sc1
    buffer_load_dwordx4 v[76:79], v1, s[12:15], s9 offen offset:2048 sc1
    s_waitcnt vmcnt(0)
L_kb_yc5:
    v_max_u32 v6, v68, v69
    v_max3_u32 v6, v6, v70, v71
    v_max3_u32 v6, v6, v72, v73
    v_max3_u32 v6, v6, v74, v75
    v_max3_u32 v6, v6, v76, v77
    v_max3_u32 v6, v6, v78, v79
    v_cmp_eq_u32 vcc, -1, v6
    s_cbranch_vccz L_kb_yk5
    s_sub_u32 s11, s11, 1
    s_cmp_lg_u32 s11, 0
    s_cbranch_scc1 L_kb_yp5
L_kb_yk5:
    ds_write_b128 v5, v[68:71] offset:30720
    ds_write_b128 v5, v[72:75] offset:31744
    ds_write_b128 v5, v[76:79] offset:32768
    s_cmp_lg_u32 s6, 12
    s_cbranch_scc1 L_kb_hexit
    s_waitcnt lgkmcnt(0)
    s_barrier
    s_lshl_b32 s38, s22, 11
    s_add_u32 s38, s38, 196608
    v_lshlrev_b32 v7, 5, v2
    s_mov_b32 s11, 262144
L_kb_sp:
    buffer_load_dwordx4 v[80:83], v7, s[12:15], s38 offen sc1
    buffer_load_dwordx4 v[84:87], v7, s[12:15], s38 offen offset:16 sc1
    s_waitcnt vmcnt(0)
L_kb_sc:
    v_max_u32 v6, v80, v81
    v_max3_u32 v6, v6, v82, v83
    v_max3_u32 v6, v6, v84, v85
    v_max3_u32 v6, v6, v86, v87
    v_cmp_eq_u32 vcc, -1, v6
    s_cbranch_vccz L_kb_sk
    s_sub_u32 s11, s11, 1
    s_cmp_lg_u32 s11, 0
    s_cbranch_scc1 L_kb_sp
L_kb_sk:
    s_waitcnt lgkmcnt(0)
    v_add_f32 v20, v80, v82
    v_add_f32 v21, v84, v86
    v_add_f32 v20, v20, v21
    v_mul_f32 v20, 0.25, v20
    v_add_f32 v21, v81, v83
    v_add_f32 v22, v85, v87
    v_add_f32 v21, v21, v22
    v_sub_f32 v80, v80, v20
    v_sub_f32 v82, v82, v20
    v_sub_f32 v84, v84, v20
    v_sub_f32 v86, v86, v20
    v_mul_f32 v22, v80, v80
    v_fmac_f32 v22, v82, v82
    v_fmac_f32 v22, v84, v84
    v_fmac_f32 v22, v86, v86
    v_fmac_f32 v21, 0x43100000, v22
    v_mov_b32 v22, 0x3727c5ac
    v_fmac_f32 v22, 0x3ae38e39, v21
    v_rsq_f32 v21, v22
    v_sqrt_f32 v22, v22
    v_sub_f32 v20, 0, v20
    v_lshlrev_b32 v5, 2, v2
    v_add_u32 v5, 160768, v5
    ds_write_b32 v5, v21
    s_mov_b32 s40, 0xffff
    v_cvt_pk_bf16_f32 v8, v20, v20
    v_lshlrev_b32 v23, 16, v8
    v_sub_f32 v20, v20, v23
    v_cvt_pk_bf16_f32 v9, v20, v20
    v_lshlrev_b32 v23, 16, v9
    v_sub_f32 v20, v20, v23
    v_cvt_pk_bf16_f32 v10, v20, v20
    v_cvt_pk_bf16_f32 v11, v22, v22
    v_lshlrev_b32 v23, 16, v11
    v_sub_f32 v22, v22, v23
    v_cvt_pk_bf16_f32 v12, v22, v22
    v_lshlrev_b32 v23, 16, v12
    v_sub_f32 v22, v22, v23
    v_cvt_pk_bf16_f32 v13, v22, v22
    v_bfi_b32 v28, s40, v8, v9
    v_bfi_b32 v29, s40, v8, v10
    v_bfi_b32 v30, s40, v9, v8
    v_bfi_b32 v31, s40, v11, v12
    v_bfi_b32 v32, s40, v11, v13
    v_bfi_b32 v33, s40, v12, v11
    v_mov_b32 v34, 0
    v_mov_b32 v35, 0
    v_mov_b32 v36, 0
    v_mov_b32 v37, 0
    v_lshrrev_b32 v5, 5, v2
    v_mul_u32_u24 v5, 38912, v5
    v_and_b32 v6, 31, v2
    v_lshl_add_u32 v5, v6, 4, v5
    ds_write_b128 v5, v[28:31] offset:36864
    ds_write_b128 v5, v[32:35] offset:37376
    ds_write_b128 v5, v[34:37] offset:37888
    ds_write_b128 v5, v[34:37] offset:38400
    s_waitcnt lgkmcnt(0)
    s_branch L_kb_hn2
L_kb_hexit:
    v_mov_b32 v5, 163328
    v_mov_b32 v6, 0
    ds_write_b32 v5, v6
    ds_write_b32 v5, v6 offset:4
    ds_write_b32 v5, v6 offset:8
    s_waitcnt lgkmcnt(0)
    s_branch L_kb_hwait
L_kb_ffn:
    s_cmp_lt_u32 s6, 9
    s_cbranch_scc1 L_kb_ring
    s_waitcnt vmcnt(0)
L_kb_ring:
    v_lshlrev_b32 v0, 9, v4
    v_lshl_add_u32 v0, v3, 4, v0
    v_add_u32 v2, 38912, v0
    v_lshlrev_b32 v5, 8, v4
    v_lshl_add_u32 v5, v3, 4, v5
    s_mul_i32 s9, s43, 512
    s_add_u32 s9, s9, 77824
    v_add_u32 v5, s9, v5
    v_cmp_gt_u32 vcc, 2, v4
    v_mov_b32 v3, 96256
    s_nop 0
    v_cndmask_b32 v3, v3, v5, vcc
    s_barrier
    ds_read_b128 v[112:115], v0 offset:0
    ds_read_b128 v[116:119], v0 offset:256
    ds_read_b128 v[120:123], v2 offset:0
    ds_read_b128 v[124:127], v2 offset:256
    s_cmp_ge_u32 s6, 9
    s_cbranch_scc1 L_kb_ring2
    buffer_load_dwordx4 v[88:91], v1, s[12:15], s40 offen offset:3072 sc1
    buffer_load_dwordx4 v[92:95], v1, s[12:15], s41 offen offset:3072 sc1
    buffer_load_dwordx4 v[96:99], v1, s[12:15], s42 offen offset:3072 sc1
    s_add_u32 s40, s40, 4096
    buffer_load_dwordx4 v[100:103], v1, s[12:15], s40 offen offset:0 sc1
    s_add_u32 s41, s41, 4096
    buffer_load_dwordx4 v[104:107], v1, s[12:15], s41 offen offset:0 sc1
    s_add_u32 s42, s42, 4096
    buffer_load_dwordx4 v[108:111], v1, s[12:15], s42 offen offset:0 sc1
L_kb_ring2:
    s_waitcnt vmcnt(13) lgkmcnt(3)
    v_mfma_f32_16x16x32_bf16 v[4:7], v[52:55], v[112:115], 0
    v_mfma_f32_16x16x32_bf16 v[20:23], v[56:59], v[112:115], 0
    v_mfma_f32_16x16x32_bf16 v[36:39], v[60:63], v[112:115], 0
    ds_read_b128 v[112:115], v0 offset:2048
    s_waitcnt lgkmcnt(3)
    v_mfma_f32_16x16x32_bf16 v[8:11], v[52:55], v[116:119], 0
    v_mfma_f32_16x16x32_bf16 v[24:27], v[56:59], v[116:119], 0
    v_mfma_f32_16x16x32_bf16 v[40:43], v[60:63], v[116:119], 0
    ds_read_b128 v[116:119], v0 offset:2304
    s_waitcnt lgkmcnt(3)
    v_mfma_f32_16x16x32_bf16 v[12:15], v[52:55], v[120:123], 0
    v_mfma_f32_16x16x32_bf16 v[28:31], v[56:59], v[120:123], 0
    v_mfma_f32_16x16x32_bf16 v[44:47], v[60:63], v[120:123], 0
    ds_read_b128 v[120:123], v2 offset:2048
    s_waitcnt lgkmcnt(3)
    v_mfma_f32_16x16x32_bf16 v[16:19], v[52:55], v[124:127], 0
    v_mfma_f32_16x16x32_bf16 v[32:35], v[56:59], v[124:127], 0
    v_mfma_f32_16x16x32_bf16 v[48:51], v[60:63], v[124:127], 0
    ds_read_b128 v[124:127], v2 offset:2304
    buffer_load_dwordx4 v[52:55], v1, s[12:15], s40 offen offset:1024 sc1
    buffer_load_dwordx4 v[56:59], v1, s[12:15], s41 offen offset:1024 sc1
    buffer_load_dwordx4 v[60:63], v1, s[12:15], s42 offen offset:1024 sc1
    s_waitcnt vmcnt(13) lgkmcnt(3)
    v_mfma_f32_16x16x32_bf16 v[4:7], v[64:67], v[112:115], v[4:7]
    v_mfma_f32_16x16x32_bf16 v[20:23], v[68:71], v[112:115], v[20:23]
    v_mfma_f32_16x16x32_bf16 v[36:39], v[72:75], v[112:115], v[36:39]
    ds_read_b128 v[112:115], v0 offset:4096
    s_waitcnt lgkmcnt(3)
    v_mfma_f32_16x16x32_bf16 v[8:11], v[64:67], v[116:119], v[8:11]
    v_mfma_f32_16x16x32_bf16 v[24:27], v[68:71], v[116:119], v[24:27]
    v_mfma_f32_16x16x32_bf16 v[40:43], v[72:75], v[116:119], v[40:43]
    ds_read_b128 v[116:119], v0 offset:4352
    s_waitcnt lgkmcnt(3)
    v_mfma_f32_16x16x32_bf16 v[12:15], v[64:67], v[120:123], v[12:15]
    v_mfma_f32_16x16x32_bf16 v[28:31], v[68:71], v[120:123], v[28:31]
    v_mfma_f32_16x16x32_bf16 v[44:47], v[72:75], v[120:123], v[44:47]
    ds_read_b128 v[120:123], v2 offset:4096
    s_waitcnt lgkmcnt(3)
    v_mfma_f32_16x16x32_bf16 v[16:19], v[64:67], v[124:127], v[16:19]
    v_mfma_f32_16x16x32_bf16 v[32:35], v[68:71], v[124:127], v[32:35]
    v_mfma_f32_16x16x32_bf16 v[48:51], v[72:75], v[124:127], v[48:51]
    ds_read_b128 v[124:127], v2 offset:4352
    buffer_load_dwordx4 v[64:67], v1, s[12:15], s40 offen offset:2048 sc1
    buffer_load_dwordx4 v[68:71], v1, s[12:15], s41 offen offset:2048 sc1
    buffer_load_dwordx4 v[72:75], v1, s[12:15], s42 offen offset:2048 sc1
    s_barrier
    s_waitcnt vmcnt(13) lgkmcnt(3)
    v_mfma_f32_16x16x32_bf16 v[4:7], v[76:79], v[112:115], v[4:7]
    v_mfma_f32_16x16x32_bf16 v[20:23], v[80:83], v[112:115], v[20:23]
    v_mfma_f32_16x16x32_bf16 v[36:39], v[84:87], v[112:115], v[36:39]
    ds_read_b128 v[112:115], v0 offset:6144
    s_waitcnt lgkmcnt(3)
    v_mfma_f32_16x16x32_bf16 v[8:11], v[76:79], v[116:119], v[8:11]
    v_mfma_f32_16x16x32_bf16 v[24:27], v[80:83], v[116:119], v[24:27]
    v_mfma_f32_16x16x32_bf16 v[40:43], v[84:87], v[116:119], v[40:43]
    ds_read_b128 v[116:119], v0 offset:6400
    s_waitcnt lgkmcnt(3)
    v_mfma_f32_16x16x32_bf16 v[12:15], v[76:79], v[120:123], v[12:15]
    v_mfma_f32_16x16x32_bf16 v[28:31], v[80:83], v[120:123], v[28:31]
    v_mfma_f32_16x16x32_bf16 v[44:47], v[84:87], v[120:123], v[44:47]
    ds_read_b128 v[120:123], v2 offset:6144
    s_waitcnt lgkmcnt(3)
    v_mfma_f32_16x16x32_bf16 v[16:19], v[76:79], v[124:127], v[16:19]
    v_mfma_f32_16x16x32_bf16 v[32:35], v[80:83], v[124:127], v[32:35]
    v_mfma_f32_16x16x32_bf16 v[48:51], v[84:87], v[124:127], v[48:51]
    ds_read_b128 v[124:127], v2 offset:6400
    buffer_load_dwordx4 v[76:79], v1, s[12:15], s40 offen offset:3072 sc1
    buffer_load_dwordx4 v[80:83], v1, s[12:15], s41 offen offset:3072 sc1
    buffer_load_dwordx4 v[84:87], v1, s[12:15], s42 offen offset:3072 sc1
    s_waitcnt vmcnt(12) lgkmcnt(3)
    v_mfma_f32_16x16x32_bf16 v[4:7], v[88:91], v[112:115], v[4:7]
    v_mfma_f32_16x16x32_bf16 v[20:23], v[92:95], v[112:115], v[20:23]
    v_mfma_f32_16x16x32_bf16 v[36:39], v[96:99], v[112:115], v[36:39]
    ds_read_b128 v[112:115], v0 offset:8192
    s_waitcnt lgkmcnt(3)
    v_mfma_f32_16x16x32_bf16 v[8:11], v[88:91], v[116:119], v[8:11]
    v_mfma_f32_16x16x32_bf16 v[24:27], v[92:95], v[116:119], v[24:27]
    v_mfma_f32_16x16x32_bf16 v[40:43], v[96:99], v[116:119], v[40:43]
    ds_read_b128 v[116:119], v0 offset:8448
    s_waitcnt lgkmcnt(3)
    v_mfma_f32_16x16x32_bf16 v[12:15], v[88:91], v[120:123], v[12:15]
    v_mfma_f32_16x16x32_bf16 v[28:31], v[92:95], v[120:123], v[28:31]
    v_mfma_f32_16x16x32_bf16 v[44:47], v[96:99], v[120:123], v[44:47]
    ds_read_b128 v[120:123], v2 offset:8192
    s_waitcnt lgkmcnt(3)
    v_mfma_f32_16x16x32_bf16 v[16:19], v[88:91], v[124:127], v[16:19]
    v_mfma_f32_16x16x32_bf16 v[32:35], v[92:95], v[124:127], v[32:35]
    v_mfma_f32_16x16x32_bf16 v[48:51], v[96:99], v[124:127], v[48:51]
    ds_read_b128 v[124:127], v2 offset:8448
    s_add_u32 s40, s40, 4096
    buffer_load_dwordx4 v[88:91], v1, s[12:15], s40 offen offset:0 sc1
    s_add_u32 s41, s41, 4096
    buffer_load_dwordx4 v[92:95], v1, s[12:15], s41 offen offset:0 sc1
    s_add_u32 s42, s42, 4096
    buffer_load_dwordx4 v[96:99], v1, s[12:15], s42 offen offset:0 sc1
    s_waitcnt vmcnt(12) lgkmcnt(3)
    v_mfma_f32_16x16x32_bf16 v[4:7], v[100:103], v[112:115], v[4:7]
    v_mfma_f32_16x16x32_bf16 v[20:23], v[104:107], v[112:115], v[20:23]
    v_mfma_f32_16x16x32_bf16 v[36:39], v[108:111], v[112:115], v[36:39]
    ds_read_b128 v[112:115], v0 offset:10240
    s_waitcnt lgkmcnt(3)
    v_mfma_f32_16x16x32_bf16 v[8:11], v[100:103], v[116:119], v[8:11]
    v_mfma_f32_16x16x32_bf16 v[24:27], v[104:107], v[116:119], v[24:27]
    v_mfma_f32_16x16x32_bf16 v[40:43], v[108:111], v[116:119], v[40:43]
    ds_read_b128 v[116:119], v0 offset:10496
    s_waitcnt lgkmcnt(3)
    v_mfma_f32_16x16x32_bf16 v[12:15], v[100:103], v[120:123], v[12:15]
    v_mfma_f32_16x16x32_bf16 v[28:31], v[104:107], v[120:123], v[28:31]
    v_mfma_f32_16x16x32_bf16 v[44:47], v[108:111], v[120:123], v[44:47]
    ds_read_b128 v[120:123], v2 offset:10240
    s_waitcnt lgkmcnt(3)
    v_mfma_f32_16x16x32_bf16 v[16:19], v[100:103], v[124:127], v[16:19]
    v_mfma_f32_16x16x32_bf16 v[32:35], v[104:107], v[124:127], v[32:35]
    v_mfma_f32_16x16x32_bf16 v[48:51], v[108:111], v[124:127], v[48:51]
    ds_read_b128 v[124:127], v2 offset:10496
    buffer_load_dwordx4 v[100:103], v1, s[12:15], s40 offen offset:1024 sc1
    buffer_load_dwordx4 v[104:107], v1, s[12:15], s41 offen offset:1024 sc1
    buffer_load_dwordx4 v[108:111], v1, s[12:15], s42 offen offset:1024 sc1
    s_barrier
    s_waitcnt vmcnt(12) lgkmcnt(3)
    v_mfma_f32_16x16x32_bf16 v[4:7], v[52:55], v[112:115], v[4:7]
    v_mfma_f32_16x16x32_bf16 v[20:23], v[56:59], v[112:115], v[20:23]
    v_mfma_f32_16x16x32_bf16 v[36:39], v[60:63], v[112:115], v[36:39]
    ds_read_b128 v[112:115], v0 offset:12288
    s_waitcnt lgkmcnt(3)
    v_mfma_f32_16x16x32_bf16 v[8:11], v[52:55], v[116:119], v[8:11]
    v_mfma_f32_16x16x32_bf16 v[24:27], v[56:59], v[116:119], v[24:27]
    v_mfma_f32_16x16x32_bf16 v[40:43], v[60:63], v[116:119], v[40:43]
    ds_read_b128 v[116:119], v0 offset:12544
    s_waitcnt lgkmcnt(3)
    v_mfma_f32_16x16x32_bf16 v[12:15], v[52:55], v[120:123], v[12:15]
    v_mfma_f32_16x16x32_bf16 v[28:31], v[56:59], v[120:123], v[28:31]
    v_mfma_f32_16x16x32_bf16 v[44:47], v[60:63], v[120:123], v[44:47]
    ds_read_b128 v[120:123], v2 offset:12288
    s_waitcnt lgkmcnt(3)
    v_mfma_f32_16x16x32_bf16 v[16:19], v[52:55], v[124:127], v[16:19]
    v_mfma_f32_16x16x32_bf16 v[32:35], v[56:59], v[124:127], v[32:35]
    v_mfma_f32_16x16x32_bf16 v[48:51], v[60:63], v[124:127], v[48:51]
    ds_read_b128 v[124:127], v2 offset:12544
    buffer_load_dwordx4 v[52:55], v1, s[12:15], s40 offen offset:2048 sc1
    buffer_load_dwordx4 v[56:59], v1, s[12:15], s41 offen offset:2048 sc1
    buffer_load_dwordx4 v[60:63], v1, s[12:15], s42 offen offset:2048 sc1
    s_waitcnt vmcnt(12) lgkmcnt(3)
    v_mfma_f32_16x16x32_bf16 v[4:7], v[64:67], v[112:115], v[4:7]
    v_mfma_f32_16x16x32_bf16 v[20:23], v[68:71], v[112:115], v[20:23]
    v_mfma_f32_16x16x32_bf16 v[36:39], v[72:75], v[112:115], v[36:39]
    ds_read_b128 v[112:115], v0 offset:14336
    s_waitcnt lgkmcnt(3)
    v_mfma_f32_16x16x32_bf16 v[8:11], v[64:67], v[116:119], v[8:11]
    v_mfma_f32_16x16x32_bf16 v[24:27], v[68:71], v[116:119], v[24:27]
    v_mfma_f32_16x16x32_bf16 v[40:43], v[72:75], v[116:119], v[40:43]
    ds_read_b128 v[116:119], v0 offset:14592
    s_waitcnt lgkmcnt(3)
    v_mfma_f32_16x16x32_bf16 v[12:15], v[64:67], v[120:123], v[12:15]
    v_mfma_f32_16x16x32_bf16 v[28:31], v[68:71], v[120:123], v[28:31]
    v_mfma_f32_16x16x32_bf16 v[44:47], v[72:75], v[120:123], v[44:47]
    ds_read_b128 v[120:123], v2 offset:14336
    s_waitcnt lgkmcnt(3)
    v_mfma_f32_16x16x32_bf16 v[16:19], v[64:67], v[124:127], v[16:19]
    v_mfma_f32_16x16x32_bf16 v[32:35], v[68:71], v[124:127], v[32:35]
    v_mfma_f32_16x16x32_bf16 v[48:51], v[72:75], v[124:127], v[48:51]
    ds_read_b128 v[124:127], v2 offset:14592
    buffer_load_dwordx4 v[64:67], v1, s[12:15], s40 offen offset:3072 sc1
    buffer_load_dwordx4 v[68:71], v1, s[12:15], s41 offen offset:3072 sc1
    buffer_load_dwordx4 v[72:75], v1, s[12:15], s42 offen offset:3072 sc1
    s_waitcnt vmcnt(12) lgkmcnt(3)
    v_mfma_f32_16x16x32_bf16 v[4:7], v[76:79], v[112:115], v[4:7]
    v_mfma_f32_16x16x32_bf16 v[20:23], v[80:83], v[112:115], v[20:23]
    v_mfma_f32_16x16x32_bf16 v[36:39], v[84:87], v[112:115], v[36:39]
    ds_read_b128 v[112:115], v0 offset:16384
    s_waitcnt lgkmcnt(3)
    v_mfma_f32_16x16x32_bf16 v[8:11], v[76:79], v[116:119], v[8:11]
    v_mfma_f32_16x16x32_bf16 v[24:27], v[80:83], v[116:119], v[24:27]
    v_mfma_f32_16x16x32_bf16 v[40:43], v[84:87], v[116:119], v[40:43]
    ds_read_b128 v[116:119], v0 offset:16640
    s_waitcnt lgkmcnt(3)
    v_mfma_f32_16x16x32_bf16 v[12:15], v[76:79], v[120:123], v[12:15]
    v_mfma_f32_16x16x32_bf16 v[28:31], v[80:83], v[120:123], v[28:31]
    v_mfma_f32_16x16x32_bf16 v[44:47], v[84:87], v[120:123], v[44:47]
    ds_read_b128 v[120:123], v2 offset:16384
    s_waitcnt lgkmcnt(3)
    v_mfma_f32_16x16x32_bf16 v[16:19], v[76:79], v[124:127], v[16:19]
    v_mfma_f32_16x16x32_bf16 v[32:35], v[80:83], v[124:127], v[32:35]
    v_mfma_f32_16x16x32_bf16 v[48:51], v[84:87], v[124:127], v[48:51]
    ds_read_b128 v[124:127], v2 offset:16640
    s_add_u32 s40, s40, 4096
    buffer_load_dwordx4 v[76:79], v1, s[12:15], s40 offen offset:0 sc1
    s_add_u32 s41, s41, 4096
    buffer_load_dwordx4 v[80:83], v1, s[12:15], s41 offen offset:0 sc1
    s_add_u32 s42, s42, 4096
    buffer_load_dwordx4 v[84:87], v1, s[12:15], s42 offen offset:0 sc1
    s_barrier
    s_waitcnt vmcnt(12) lgkmcnt(3)
    v_mfma_f32_16x16x32_bf16 v[4:7], v[88:91], v[112:115], v[4:7]
    v_mfma_f32_16x16x32_bf16 v[20:23], v[92:95], v[112:115], v[20:23]
    v_mfma_f32_16x16x32_bf16 v[36:39], v[96:99], v[112:115], v[36:39]
    ds_read_b128 v[112:115], v0 offset:18432
    s_waitcnt lgkmcnt(3)
    v_mfma_f32_16x16x32_bf16 v[8:11], v[88:91], v[116:119], v[8:11]
    v_mfma_f32_16x16x32_bf16 v[24:27], v[92:95], v[116:119], v[24:27]
    v_mfma_f32_16x16x32_bf16 v[40:43], v[96:99], v[116:119], v[40:43]
    ds_read_b128 v[116:119], v0 offset:18688
    s_waitcnt lgkmcnt(3)
    v_mfma_f32_16x16x32_bf16 v[12:15], v[88:91], v[120:123], v[12:15]
    v_mfma_f32_16x16x32_bf16 v[28:31], v[92:95], v[120:123], v[28:31]
    v_mfma_f32_16x16x32_bf16 v[44:47], v[96:99], v[120:123], v[44:47]
    ds_read_b128 v[120:123], v2 offset:18432
    s_waitcnt lgkmcnt(3)
    v_mfma_f32_16x16x32_bf16 v[16:19], v[88:91], v[124:127], v[16:19]
    v_mfma_f32_16x16x32_bf16 v[32:35], v[92:95], v[124:127], v[32:35]
    v_mfma_f32_16x16x32_bf16 v[48:51], v[96:99], v[124:127], v[48:51]
    ds_read_b128 v[124:127], v2 offset:18688
    buffer_load_dwordx4 v[88:91], v1, s[12:15], s40 offen offset:1024 sc1
    buffer_load_dwordx4 v[92:95], v1, s[12:15], s41 offen offset:1024 sc1
    buffer_load_dwordx4 v[96:99], v1, s[12:15], s42 offen offset:1024 sc1
    s_waitcnt vmcnt(12) lgkmcnt(3)
    v_mfma_f32_16x16x32_bf16 v[4:7], v[100:103], v[112:115], v[4:7]
    v_mfma_f32_16x16x32_bf16 v[20:23], v[104:107], v[112:115], v[20:23]
    v_mfma_f32_16x16x32_bf16 v[36:39], v[108:111], v[112:115], v[36:39]
    ds_read_b128 v[112:115], v0 offset:20480
    s_waitcnt lgkmcnt(3)
    v_mfma_f32_16x16x32_bf16 v[8:11], v[100:103], v[116:119], v[8:11]
    v_mfma_f32_16x16x32_bf16 v[24:27], v[104:107], v[116:119], v[24:27]
    v_mfma_f32_16x16x32_bf16 v[40:43], v[108:111], v[116:119], v[40:43]
    ds_read_b128 v[116:119], v0 offset:20736
    s_waitcnt lgkmcnt(3)
    v_mfma_f32_16x16x32_bf16 v[12:15], v[100:103], v[120:123], v[12:15]
    v_mfma_f32_16x16x32_bf16 v[28:31], v[104:107], v[120:123], v[28:31]
    v_mfma_f32_16x16x32_bf16 v[44:47], v[108:111], v[120:123], v[44:47]
    ds_read_b128 v[120:123], v2 offset:20480
    s_waitcnt lgkmcnt(3)
    v_mfma_f32_16x16x32_bf16 v[16:19], v[100:103], v[124:127], v[16:19]
    v_mfma_f32_16x16x32_bf16 v[32:35], v[104:107], v[124:127], v[32:35]
    v_mfma_f32_16x16x32_bf16 v[48:51], v[108:111], v[124:127], v[48:51]
    ds_read_b128 v[124:127], v2 offset:20736
    buffer_load_dwordx4 v[100:103], v1, s[12:15], s40 offen offset:2048 sc1
    buffer_load_dwordx4 v[104:107], v1, s[12:15], s41 offen offset:2048 sc1
    buffer_load_dwordx4 v[108:111], v1, s[12:15], s42 offen offset:2048 sc1
    s_waitcnt vmcnt(12) lgkmcnt(3)
    v_mfma_f32_16x16x32_bf16 v[4:7], v[52:55], v[112:115], v[4:7]
    v_mfma_f32_16x16x32_bf16 v[20:23], v[56:59], v[112:115], v[20:23]
    v_mfma_f32_16x16x32_bf16 v[36:39], v[60:63], v[112:115], v[36:39]
    ds_read_b128 v[112:115], v0 offset:22528
    s_waitcnt lgkmcnt(3)
    v_mfma_f32_16x16x32_bf16 v[8:11], v[52:55], v[116:119], v[8:11]
    v_mfma_f32_16x16x32_bf16 v[24:27], v[56:59], v[116:119], v[24:27]
    v_mfma_f32_16x16x32_bf16 v[40:43], v[60:63], v[116:119], v[40:43]
    ds_read_b128 v[116:119], v0 offset:22784
    s_waitcnt lgkmcnt(3)
    v_mfma_f32_16x16x32_bf16 v[12:15], v[52:55], v[120:123], v[12:15]
    v_mfma_f32_16x16x32_bf16 v[28:31], v[56:59], v[120:123], v[28:31]
    v_mfma_f32_16x16x32_bf16 v[44:47], v[60:63], v[120:123], v[44:47]
    ds_read_b128 v[120:123], v2 offset:22528
    s_waitcnt lgkmcnt(3)
    v_mfma_f32_16x16x32_bf16 v[16:19], v[52:55], v[124:127], v[16:19]
    v_mfma_f32_16x16x32_bf16 v[32:35], v[56:59], v[124:127], v[32:35]
    v_mfma_f32_16x16x32_bf16 v[48:51], v[60:63], v[124:127], v[48:51]
    ds_read_b128 v[124:127], v2 offset:22784
    buffer_load_dwordx4 v[52:55], v1, s[12:15], s40 offen offset:3072 sc1
    buffer_load_dwordx4 v[56:59], v1, s[12:15], s41 offen offset:3072 sc1
    buffer_load_dwordx4 v[60:63], v1, s[12:15], s42 offen offset:3072 sc1
    s_barrier
    s_waitcnt vmcnt(12) lgkmcnt(3)
    v_mfma_f32_16x16x32_bf16 v[4:7], v[64:67], v[112:115], v[4:7]
    v_mfma_f32_16x16x32_bf16 v[20:23], v[68:71], v[112:115], v[20:23]
    v_mfma_f32_16x16x32_bf16 v[36:39], v[72:75], v[112:115], v[36:39]
    ds_read_b128 v[112:115], v0 offset:24576
    s_waitcnt lgkmcnt(3)
    v_mfma_f32_16x16x32_bf16 v[8:11], v[64:67], v[116:119], v[8:11]
    v_mfma_f32_16x16x32_bf16 v[24:27], v[68:71], v[116:119], v[24:27]
    v_mfma_f32_16x16x32_bf16 v[40:43], v[72:75], v[116:119], v[40:43]
    ds_read_b128 v[116:119], v0 offset:24832
    s_waitcnt lgkmcnt(3)
    v_mfma_f32_16x16x32_bf16 v[12:15], v[64:67], v[120:123], v[12:15]
    v_mfma_f32_16x16x32_bf16 v[28:31], v[68:71], v[120:123], v[28:31]
    v_mfma_f32_16x16x32_bf16 v[44:47], v[72:75], v[120:123], v[44:47]
    ds_read_b128 v[120:123], v2 offset:24576
    s_waitcnt lgkmcnt(3)
    v_mfma_f32_16x16x32_bf16 v[16:19], v[64:67], v[124:127], v[16:19]
    v_mfma_f32_16x16x32_bf16 v[32:35], v[68:71], v[124:127], v[32:35]
    v_mfma_f32_16x16x32_bf16 v[48:51], v[72:75], v[124:127], v[48:51]
    ds_read_b128 v[124:127], v2 offset:24832
    s_add_u32 s40, s40, 4096
    buffer_load_dwordx4 v[64:67], v1, s[12:15], s40 offen offset:0 sc1
    s_add_u32 s41, s41, 4096
    buffer_load_dwordx4 v[68:71], v1, s[12:15], s41 offen offset:0 sc1
    s_add_u32 s42, s42, 4096
    buffer_load_dwordx4 v[72:75], v1, s[12:15], s42 offen offset:0 sc1
    s_waitcnt vmcnt(12) lgkmcnt(3)
    v_mfma_f32_16x16x32_bf16 v[4:7], v[76:79], v[112:115], v[4:7]
    v_mfma_f32_16x16x32_bf16 v[20:23], v[80:83], v[112:115], v[20:23]
    v_mfma_f32_16x16x32_bf16 v[36:39], v[84:87], v[112:115], v[36:39]
    ds_read_b128 v[112:115], v0 offset:26624
    s_waitcnt lgkmcnt(3)
    v_mfma_f32_16x16x32_bf16 v[8:11], v[76:79], v[116:119], v[8:11]
    v_mfma_f32_16x16x32_bf16 v[24:27], v[80:83], v[116:119], v[24:27]
    v_mfma_f32_16x16x32_bf16 v[40:43], v[84:87], v[116:119], v[40:43]
    ds_read_b128 v[116:119], v0 offset:26880
    s_waitcnt lgkmcnt(3)
    v_mfma_f32_16x16x32_bf16 v[12:15], v[76:79], v[120:123], v[12:15]
    v_mfma_f32_16x16x32_bf16 v[28:31], v[80:83], v[120:123], v[28:31]
    v_mfma_f32_16x16x32_bf16 v[44:47], v[84:87], v[120:123], v[44:47]
    ds_read_b128 v[120:123], v2 offset:26624
    s_waitcnt lgkmcnt(3)
    v_mfma_f32_16x16x32_bf16 v[16:19], v[76:79], v[124:127], v[16:19]
    v_mfma_f32_16x16x32_bf16 v[32:35], v[80:83], v[124:127], v[32:35]
    v_mfma_f32_16x16x32_bf16 v[48:51], v[84:87], v[124:127], v[48:51]
    ds_read_b128 v[124:127], v2 offset:26880
    buffer_load_dwordx4 v[76:79], v1, s[12:15], s40 offen offset:1024 sc1
    buffer_load_dwordx4 v[80:83], v1, s[12:15], s41 offen offset:1024 sc1
    buffer_load_dwordx4 v[84:87], v1, s[12:15], s42 offen offset:1024 sc1
    s_waitcnt vmcnt(12) lgkmcnt(3)
    v_mfma_f32_16x16x32_bf16 v[4:7], v[88:91], v[112:115], v[4:7]
    v_mfma_f32_16x16x32_bf16 v[20:23], v[92:95], v[112:115], v[20:23]
    v_mfma_f32_16x16x32_bf16 v[36:39], v[96:99], v[112:115], v[36:39]
    ds_read_b128 v[112:115], v0 offset:28672
    s_waitcnt lgkmcnt(3)
    v_mfma_f32_16x16x32_bf16 v[8:11], v[88:91], v[116:119], v[8:11]
    v_mfma_f32_16x16x32_bf16 v[24:27], v[92:95], v[116:119], v[24:27]
    v_mfma_f32_16x16x32_bf16 v[40:43], v[96:99], v[116:119], v[40:43]
    ds_read_b128 v[116:119], v0 offset:28928
    s_waitcnt lgkmcnt(3)
    v_mfma_f32_16x16x32_bf16 v[12:15], v[88:91], v[120:123], v[12:15]
    v_mfma_f32_16x16x32_bf16 v[28:31], v[92:95], v[120:123], v[28:31]
    v_mfma_f32_16x16x32_bf16 v[44:47], v[96:99], v[120:123], v[44:47]
    ds_read_b128 v[120:123], v2 offset:28672
    s_waitcnt lgkmcnt(3)
    v_mfma_f32_16x16x32_bf16 v[16:19], v[88:91], v[124:127], v[16:19]
    v_mfma_f32_16x16x32_bf16 v[32:35], v[92:95], v[124:127], v[32:35]
    v_mfma_f32_16x16x32_bf16 v[48:51], v[96:99], v[124:127], v[48:51]
    ds_read_b128 v[124:127], v2 offset:28928
    s_waitcnt lgkmcnt(0)
    ds_read_b128 v[88:91], v3 offset:0
    ds_read_b128 v[92:95], v3 offset:512
    ds_read_b128 v[96:99], v3 offset:1024
    s_barrier
    s_waitcnt vmcnt(9) lgkmcnt(3)
    v_mfma_f32_16x16x32_bf16 v[4:7], v[100:103], v[112:115], v[4:7]
    v_mfma_f32_16x16x32_bf16 v[20:23], v[104:107], v[112:115], v[20:23]
    v_mfma_f32_16x16x32_bf16 v[36:39], v[108:111], v[112:115], v[36:39]
    ds_read_b128 v[112:115], v0 offset:30720
    s_waitcnt lgkmcnt(3)
    v_mfma_f32_16x16x32_bf16 v[8:11], v[100:103], v[116:119], v[8:11]
    v_mfma_f32_16x16x32_bf16 v[24:27], v[104:107], v[116:119], v[24:27]
    v_mfma_f32_16x16x32_bf16 v[40:43], v[108:111], v[116:119], v[40:43]
    ds_read_b128 v[116:119], v0 offset:30976
    s_waitcnt lgkmcnt(3)
    v_mfma_f32_16x16x32_bf16 v[12:15], v[100:103], v[120:123], v[12:15]
    v_mfma_f32_16x16x32_bf16 v[28:31], v[104:107], v[120:123], v[28:31]
    v_mfma_f32_16x16x32_bf16 v[44:47], v[108:111], v[120:123], v[44:47]
    ds_read_b128 v[120:123], v2 offset:30720
    s_waitcnt lgkmcnt(3)
    v_mfma_f32_16x16x32_bf16 v[16:19], v[100:103], v[124:127], v[16:19]
    v_mfma_f32_16x16x32_bf16 v[32:35], v[104:107], v[124:127], v[32:35]
    v_mfma_f32_16x16x32_bf16 v[48:51], v[108:111], v[124:127], v[48:51]
    ds_read_b128 v[124:127], v2 offset:30976
    buffer_load_dwordx4 v[100:103], v1, s[12:15], s44 offen offset:0 sc1
    buffer_load_dwordx4 v[104:107], v1, s[12:15], s44 offen offset:1024 sc1
    buffer_load_dwordx4 v[108:111], v1, s[12:15], s44 offen offset:2048 sc1
    s_waitcnt vmcnt(9) lgkmcnt(3)
    v_mfma_f32_16x16x32_bf16 v[4:7], v[52:55], v[112:115], v[4:7]
    v_mfma_f32_16x16x32_bf16 v[20:23], v[56:59], v[112:115], v[20:23]
    v_mfma_f32_16x16x32_bf16 v[36:39], v[60:63], v[112:115], v[36:39]
    ds_read_b128 v[112:115], v0 offset:32768
    s_waitcnt lgkmcnt(3)
    v_mfma_f32_16x16x32_bf16 v[8:11], v[52:55], v[116:119], v[8:11]
    v_mfma_f32_16x16x32_bf16 v[24:27], v[56:59], v[116:119], v[24:27]
    v_mfma_f32_16x16x32_bf16 v[40:43], v[60:63], v[116:119], v[40:43]
    ds_read_b128 v[116:119], v0 offset:33024
    s_waitcnt lgkmcnt(3)
    v_mfma_f32_16x16x32_bf16 v[12:15], v[52:55], v[120:123], v[12:15]
    v_mfma_f32_16x16x32_bf16 v[28:31], v[56:59], v[120:123], v[28:31]
    v_mfma_f32_16x16x32_bf16 v[44:47], v[60:63], v[120:123], v[44:47]
    ds_read_b128 v[120:123], v2 offset:32768
    s_waitcnt lgkmcnt(3)
    v_mfma_f32_16x16x32_bf16 v[16:19], v[52:55], v[124:127], v[16:19]
    v_mfma_f32_16x16x32_bf16 v[32:35], v[56:59], v[124:127], v[32:35]
    v_mfma_f32_16x16x32_bf16 v[48:51], v[60:63], v[124:127], v[48:51]
    ds_read_b128 v[124:127], v2 offset:33024
    buffer_load_dwordx4 v[52:55], v1, s[12:15], s44 offen offset:3072 sc1
    s_add_u32 s44, s44, 4096
    buffer_load_dwordx4 v[56:59], v1, s[12:15], s44 offen offset:0 sc1
    buffer_load_dwordx4 v[60:63], v1, s[12:15], s44 offen offset:1024 sc1
    s_waitcnt vmcnt(9) lgkmcnt(3)
    v_mfma_f32_16x16x32_bf16 v[4:7], v[64:67], v[112:115], v[4:7]
    v_mfma_f32_16x16x32_bf16 v[20:23], v[68:71], v[112:115], v[20:23]
    v_mfma_f32_16x16x32_bf16 v[36:39], v[72:75], v[112:115], v[36:39]
    ds_read_b128 v[112:115], v0 offset:34816
    s_waitcnt lgkmcnt(3)
    v_mfma_f32_16x16x32_bf16 v[8:11], v[64:67], v[116:119], v[8:11]
    v_mfma_f32_16x16x32_bf16 v[24:27], v[68:71], v[116:119], v[24:27]
    v_mfma_f32_16x16x32_bf16 v[40:43], v[72:75], v[116:119], v[40:43]
    ds_read_b128 v[116:119], v0 offset:35072
    s_waitcnt lgkmcnt(3)
    v_mfma_f32_16x16x32_bf16 v[12:15], v[64:67], v[120:123], v[12:15]
    v_mfma_f32_16x16x32_bf16 v[28:31], v[68:71], v[120:123], v[28:31]
    v_mfma_f32_16x16x32_bf16 v[44:47], v[72:75], v[120:123], v[44:47]
    ds_read_b128 v[120:123], v2 offset:34816
    s_waitcnt lgkmcnt(3)
    v_mfma_f32_16x16x32_bf16 v[16:19], v[64:67], v[124:127], v[16:19]
    v_mfma_f32_16x16x32_bf16 v[32:35], v[68:71], v[124:127], v[32:35]
    v_mfma_f32_16x16x32_bf16 v[48:51], v[72:75], v[124:127], v[48:51]
    ds_read_b128 v[124:127], v2 offset:35072
    buffer_load_dwordx4 v[64:67], v1, s[12:15], s44 offen offset:2048 sc1
    buffer_load_dwordx4 v[68:71], v1, s[12:15], s44 offen offset:3072 sc1
    s_add_u32 s44, s44, 4096
    buffer_load_dwordx4 v[72:75], v1, s[12:15], s44 offen offset:0 sc1
    s_barrier
    s_waitcnt vmcnt(9) lgkmcnt(3)
    v_mfma_f32_16x16x32_bf16 v[4:7], v[76:79], v[112:115], v[4:7]
    v_mfma_f32_16x16x32_bf16 v[20:23], v[80:83], v[112:115], v[20:23]
    v_mfma_f32_16x16x32_bf16 v[36:39], v[84:87], v[112:115], v[36:39]
    ds_read_b128 v[112:115], v0 offset:36864
    s_waitcnt lgkmcnt(3)
    v_mfma_f32_16x16x32_bf16 v[8:11], v[76:79], v[116:119], v[8:11]
    v_mfma_f32_16x16x32_bf16 v[24:27], v[80:83], v[116:119], v[24:27]
    v_mfma_f32_16x16x32_bf16 v[40:43], v[84:87], v[116:119], v[40:43]
    ds_read_b128 v[116:119], v0 offset:37120
    s_waitcnt lgkmcnt(3)
    v_mfma_f32_16x16x32_bf16 v[12:15], v[76:79], v[120:123], v[12:15]
    v_mfma_f32_16x16x32_bf16 v[28:31], v[80:83], v[120:123], v[28:31]
    v_mfma_f32_16x16x32_bf16 v[44:47], v[84:87], v[120:123], v[44:47]
    ds_read_b128 v[120:123], v2 offset:36864
    s_waitcnt lgkmcnt(3)
    v_mfma_f32_16x16x32_bf16 v[16:19], v[76:79], v[124:127], v[16:19]
    v_mfma_f32_16x16x32_bf16 v[32:35], v[80:83], v[124:127], v[32:35]
    v_mfma_f32_16x16x32_bf16 v[48:51], v[84:87], v[124:127], v[48:51]
    ds_read_b128 v[124:127], v2 offset:37120
    buffer_load_dwordx4 v[76:79], v1, s[12:15], s44 offen offset:1024 sc1
    buffer_load_dwordx4 v[80:83], v1, s[12:15], s44 offen offset:2048 sc1
    buffer_load_dwordx4 v[84:87], v1, s[12:15], s44 offen offset:3072 sc1
    s_waitcnt lgkmcnt(3)
    v_mfma_f32_16x16x32_bf16 v[4:7], v[88:91], v[112:115], v[4:7]
    v_mfma_f32_16x16x32_bf16 v[20:23], v[92:95], v[112:115], v[20:23]
    v_mfma_f32_16x16x32_bf16 v[36:39], v[96:99], v[112:115], v[36:39]
    s_waitcnt lgkmcnt(2)
    v_mfma_f32_16x16x32_bf16 v[8:11], v[88:91], v[116:119], v[8:11]
    v_mfma_f32_16x16x32_bf16 v[24:27], v[92:95], v[116:119], v[24:27]
    v_mfma_f32_16x16x32_bf16 v[40:43], v[96:99], v[116:119], v[40:43]
    s_waitcnt lgkmcnt(1)
    v_mfma_f32_16x16x32_bf16 v[12:15], v[88:91], v[120:123], v[12:15]
    v_mfma_f32_16x16x32_bf16 v[28:31], v[92:95], v[120:123], v[28:31]
    v_mfma_f32_16x16x32_bf16 v[44:47], v[96:99], v[120:123], v[44:47]
    s_waitcnt lgkmcnt(0)
    v_mfma_f32_16x16x32_bf16 v[16:19], v[88:91], v[124:127], v[16:19]
    v_mfma_f32_16x16x32_bf16 v[32:35], v[92:95], v[124:127], v[32:35]
    v_mfma_f32_16x16x32_bf16 v[48:51], v[96:99], v[124:127], v[48:51]
    s_add_u32 s44, s44, 4096
    buffer_load_dwordx4 v[88:91], v1, s[12:15], s44 offen offset:0 sc1
    buffer_load_dwordx4 v[92:95], v1, s[12:15], s44 offen offset:1024 sc1
    buffer_load_dwordx4 v[96:99], v1, s[12:15], s44 offen offset:2048 sc1
    v_lshrrev_b32 v112, 4, v1
    v_lshrrev_b32 v113, 4, v112
    v_and_b32 v112, 15, v112
    v_lshrrev_b32 v3, 1, v113
    v_lshlrev_b32 v3, 10, v3
    v_lshl_add_u32 v3, v112, 4, v3
    v_and_b32 v114, 1, v113
    v_lshl_add_u32 v3, v114, 3, v3
    s_lshl_b32 s9, s43, 11
    s_add_u32 s9, s9, 77824
    v_add_u32 v3, s9, v3
    v_lshlrev_b32 v0, 10, v113
    v_lshl_add_u32 v0, v112, 4, v0
    v_add_u32 v0, 77824, v0
    v_add_u32 v2, 36864, v0
    v_lshlrev_b32 v115, 2, v112
    v_add_u32 v115, 160768, v115
    ds_read_b32 v116, v115 offset:0
    ds_read_b32 v118, v115 offset:64
    ds_read_b32 v120, v115 offset:128
    ds_read_b32 v122, v115 offset:192
    s_waitcnt lgkmcnt(0)
    v_pk_mul_f32 v[4:5], v[4:5], v[116:117] op_sel_hi:[1,0]
    v_pk_mul_f32 v[6:7], v[6:7], v[116:117] op_sel_hi:[1,0]
    v_cvt_pk_bf16_f32 v4, v4, v5
    v_cvt_pk_bf16_f32 v5, v6, v7
    v_pk_max_i16 v4, v4, 0
    v_pk_max_i16 v5, v5, 0
    ds_write_b64 v3, v[4:5] offset:0
    v_pk_mul_f32 v[20:21], v[20:21], v[116:117] op_sel_hi:[1,0]
    v_pk_mul_f32 v[22:23], v[22:23], v[116:117] op_sel_hi:[1,0]
    v_cvt_pk_bf16_f32 v20, v20, v21
    v_cvt_pk_bf16_f32 v21, v22, v23
    v_pk_max_i16 v20, v20, 0
    v_pk_max_i16 v21, v21, 0
    ds_write_b64 v3, v[20:21] offset:2048
    v_pk_mul_f32 v[36:37], v[36:37], v[116:117] op_sel_hi:[1,0]
    v_pk_mul_f32 v[38:39], v[38:39], v[116:117] op_sel_hi:[1,0]
    v_cvt_pk_bf16_f32 v36, v36, v37
    v_cvt_pk_bf16_f32 v37, v38, v39
    v_pk_max_i16 v36, v36, 0
    v_pk_max_i16 v37, v37, 0
    ds_write_b64 v3, v[36:37] offset:4096
    v_pk_mul_f32 v[8:9], v[8:9], v[118:119] op_sel_hi:[1,0]
    v_pk_mul_f32 v[10:11], v[10:11], v[118:119] op_sel_hi:[1,0]
    v_cvt_pk_bf16_f32 v8, v8, v9
    v_cvt_pk_bf16_f32 v9, v10, v11
    v_pk_max_i16 v8, v8, 0
    v_pk_max_i16 v9, v9, 0
    ds_write_b64 v3, v[8:9] offset:256
    v_pk_mul_f32 v[24:25], v[24:25], v[118:119] op_sel_hi:[1,0]
    v_pk_mul_f32 v[26:27], v[26:27], v[118:119] op_sel_hi:[1,0]
    v_cvt_pk_bf16_f32 v24, v24, v25
    v_cvt_pk_bf16_f32 v25, v26, v27
    v_pk_max_i16 v24, v24, 0
    v_pk_max_i16 v25, v25, 0
    ds_write_b64 v3, v[24:25] offset:2304
    v_pk_mul_f32 v[40:41], v[40:41], v[118:119] op_sel_hi:[1,0]
    v_pk_mul_f32 v[42:43], v[42:43], v[118:119] op_sel_hi:[1,0]
    v_cvt_pk_bf16_f32 v40, v40, v41
    v_cvt_pk_bf16_f32 v41, v42, v43
    v_pk_max_i16 v40, v40, 0
    v_pk_max_i16 v41, v41, 0
    ds_write_b64 v3, v[40:41] offset:4352
    v_pk_mul_f32 v[12:13], v[12:13], v[120:121] op_sel_hi:[1,0]
    v_pk_mul_f32 v[14:15], v[14:15], v[120:121] op_sel_hi:[1,0]
    v_cvt_pk_bf16_f32 v12, v12, v13
    v_cvt_pk_bf16_f32 v13, v14, v15
    v_pk_max_i16 v12, v12, 0
    v_pk_max_i16 v13, v13, 0
    ds_write_b64 v3, v[12:13] offset:512
    v_pk_mul_f32 v[28:29], v[28:29], v[120:121] op_sel_hi:[1,0]
    v_pk_mul_f32 v[30:31], v[30:31], v[120:121] op_sel_hi:[1,0]
    v_cvt_pk_bf16_f32 v28, v28, v29
    v_cvt_pk_bf16_f32 v29, v30, v31
    v_pk_max_i16 v28, v28, 0
    v_pk_max_i16 v29, v29, 0
    ds_write_b64 v3, v[28:29] offset:2560
    v_pk_mul_f32 v[44:45], v[44:45], v[120:121] op_sel_hi:[1,0]
    v_pk_mul_f32 v[46:47], v[46:47], v[120:121] op_sel_hi:[1,0]
    v_cvt_pk_bf16_f32 v44, v44, v45
    v_cvt_pk_bf16_f32 v45, v46, v47
    v_pk_max_i16 v44, v44, 0
    v_pk_max_i16 v45, v45, 0
    ds_write_b64 v3, v[44:45] offset:4608
    v_pk_mul_f32 v[16:17], v[16:17], v[122:123] op_sel_hi:[1,0]
    v_pk_mul_f32 v[18:19], v[18:19], v[122:123] op_sel_hi:[1,0]
    v_cvt_pk_bf16_f32 v16, v16, v17
    v_cvt_pk_bf16_f32 v17, v18, v19
    v_pk_max_i16 v16, v16, 0
    v_pk_max_i16 v17, v17, 0
    ds_write_b64 v3, v[16:17] offset:768
    v_pk_mul_f32 v[32:33], v[32:33], v[122:123] op_sel_hi:[1,0]
    v_pk_mul_f32 v[34:35], v[34:35], v[122:123] op_sel_hi:[1,0]
    v_cvt_pk_bf16_f32 v32, v32, v33
    v_cvt_pk_bf16_f32 v33, v34, v35
    v_pk_max_i16 v32, v32, 0
    v_pk_max_i16 v33, v33, 0
    ds_write_b64 v3, v[32:33] offset:2816
    v_pk_mul_f32 v[48:49], v[48:49], v[122:123] op_sel_hi:[1,0]
    v_pk_mul_f32 v[50:51], v[50:51], v[122:123] op_sel_hi:[1,0]
    v_cvt_pk_bf16_f32 v48, v48, v49
    v_cvt_pk_bf16_f32 v49, v50, v51
    v_pk_max_i16 v48, v48, 0
    v_pk_max_i16 v49, v49, 0
    ds_write_b64 v3, v[48:49] offset:4864
    s_mul_i32 s9, s6, 21846
    s_lshr_b32 s9, s9, 16
    s_mul_i32 s10, s9, 3
    s_sub_u32 s10, s6, s10
    s_mul_i32 s10, s10, 3072
    s_lshl_b32 s11, s22, 3
    s_add_u32 s9, s9, s11
    s_lshl_b32 s9, s9, 3
    s_add_u32 s9, s9, s23
    s_mul_i32 s9, s9, 9216
    s_add_u32 s9, s9, s10
    s_add_u32 s50, s9, 33554432
    s_add_u32 s51, s50, 294912
    s_lshl_b32 s56, s22, 7
    s_lshl_b32 s11, s23, 2
    s_add_u32 s56, s56, s11
    s_waitcnt lgkmcnt(0)
    s_barrier
    s_setprio 2
    ds_read_b128 v[112:115], v0 offset:0
    ds_read_b128 v[116:119], v0 offset:256
    ds_read_b128 v[120:123], v0 offset:512
    ds_read_b128 v[124:127], v0 offset:768
    ds_read_b128 v[4:7], v0 offset:4096
    ds_read_b128 v[8:11], v0 offset:4352
    ds_read_b128 v[12:15], v0 offset:4608
    ds_read_b128 v[16:19], v0 offset:4864
    ds_read_b128 v[20:23], v0 offset:8192
    ds_read_b128 v[24:27], v0 offset:8448
    ds_read_b128 v[28:31], v0 offset:8704
    ds_read_b128 v[32:35], v0 offset:8960
    s_waitcnt vmcnt(14) lgkmcnt(8)
    v_mfma_f32_16x16x32_bf16 v[36:39], v[100:103], v[112:115], 0
    v_mfma_f32_16x16x32_bf16 v[40:43], v[100:103], v[116:119], 0
    v_mfma_f32_16x16x32_bf16 v[44:47], v[100:103], v[120:123], 0
    v_mfma_f32_16x16x32_bf16 v[48:51], v[100:103], v[124:127], 0
    buffer_load_dwordx4 v[100:103], v1, s[12:15], s44 offen offset:3072 sc1
    ds_read_b128 v[112:115], v0 offset:12288
    ds_read_b128 v[116:119], v0 offset:12544
    ds_read_b128 v[120:123], v0 offset:12800
    ds_read_b128 v[124:127], v0 offset:13056
    s_waitcnt vmcnt(14) lgkmcnt(8)
    v_mfma_f32_16x16x32_bf16 v[36:39], v[104:107], v[4:7], v[36:39]
    v_mfma_f32_16x16x32_bf16 v[40:43], v[104:107], v[8:11], v[40:43]
    v_mfma_f32_16x16x32_bf16 v[44:47], v[104:107], v[12:15], v[44:47]
    v_mfma_f32_16x16x32_bf16 v[48:51], v[104:107], v[16:19], v[48:51]
    s_add_u32 s44, s44, 4096
    buffer_load_dwordx4 v[104:107], v1, s[12:15], s44 offen offset:0 sc1
    ds_read_b128 v[4:7], v0 offset:16384
    ds_read_b128 v[8:11], v0 offset:16640
    ds_read_b128 v[12:15], v0 offset:16896
    ds_read_b128 v[16:19], v0 offset:17152
    s_waitcnt vmcnt(14) lgkmcnt(8)
    v_mfma_f32_16x16x32_bf16 v[36:39], v[108:111], v[20:23], v[36:39]
    v_mfma_f32_16x16x32_bf16 v[40:43], v[108:111], v[24:27], v[40:43]
    v_mfma_f32_16x16x32_bf16 v[44:47], v[108:111], v[28:31], v[44:47]
    v_mfma_f32_16x16x32_bf16 v[48:51], v[108:111], v[32:35], v[48:51]
    buffer_load_dwordx4 v[108:111], v1, s[12:15], s44 offen offset:1024 sc1
    ds_read_b128 v[20:23], v0 offset:20480
    ds_read_b128 v[24:27], v0 offset:20736
    ds_read_b128 v[28:31], v0 offset:20992
    ds_read_b128 v[32:35], v0 offset:21248
    s_waitcnt vmcnt(14) lgkmcnt(8)
    v_mfma_f32_16x16x32_bf16 v[36:39], v[52:55], v[112:115], v[36:39]
    v_mfma_f32_16x16x32_bf16 v[40:43], v[52:55], v[116:119], v[40:43]
    v_mfma_f32_16x16x32_bf16 v[44:47], v[52:55], v[120:123], v[44:47]
    v_mfma_f32_16x16x32_bf16 v[48:51], v[52:55], v[124:127], v[48:51]
    buffer_load_dwordx4 v[52:55], v1, s[12:15], s45 offen offset:0 sc1
    ds_read_b128 v[112:115], v0 offset:24576
    ds_read_b128 v[116:119], v0 offset:24832
    ds_read_b128 v[120:123], v0 offset:25088
    ds_read_b128 v[124:127], v0 offset:25344
    s_waitcnt vmcnt(14) lgkmcnt(8)
    v_mfma_f32_16x16x32_bf16 v[36:39], v[56:59], v[4:7], v[36:39]
    v_mfma_f32_16x16x32_bf16 v[40:43], v[56:59], v[8:11], v[40:43]
    v_mfma_f32_16x16x32_bf16 v[44:47], v[56:59], v[12:15], v[44:47]
    v_mfma_f32_16x16x32_bf16 v[48:51], v[56:59], v[16:19], v[48:51]
    buffer_load_dwordx4 v[56:59], v1, s[12:15], s45 offen offset:1024 sc1
    ds_read_b128 v[4:7], v0 offset:28672
    ds_read_b128 v[8:11], v0 offset:28928
    ds_read_b128 v[12:15], v0 offset:29184
    ds_read_b128 v[16:19], v0 offset:29440
    s_waitcnt vmcnt(14) lgkmcnt(8)
    v_mfma_f32_16x16x32_bf16 v[36:39], v[60:63], v[20:23], v[36:39]
    v_mfma_f32_16x16x32_bf16 v[40:43], v[60:63], v[24:27], v[40:43]
    v_mfma_f32_16x16x32_bf16 v[44:47], v[60:63], v[28:31], v[44:47]
    v_mfma_f32_16x16x32_bf16 v[48:51], v[60:63], v[32:35], v[48:51]
    buffer_load_dwordx4 v[60:63], v1, s[12:15], s45 offen offset:2048 sc1
    ds_read_b128 v[20:23], v0 offset:32768
    ds_read_b128 v[24:27], v0 offset:33024
    ds_read_b128 v[28:31], v0 offset:33280
    ds_read_b128 v[32:35], v0 offset:33536
    s_waitcnt vmcnt(14) lgkmcnt(8)
    v_mfma_f32_16x16x32_bf16 v[36:39], v[64:67], v[112:115], v[36:39]
    v_mfma_f32_16x16x32_bf16 v[40:43], v[64:67], v[116:119], v[40:43]
    v_mfma_f32_16x16x32_bf16 v[44:47], v[64:67], v[120:123], v[44:47]
    v_mfma_f32_16x16x32_bf16 v[48:51], v[64:67], v[124:127], v[48:51]
    buffer_load_dwordx4 v[64:67], v1, s[12:15], s45 offen offset:3072 sc1
    ds_read_b128 v[112:115], v2 offset:0
    ds_read_b128 v[116:119], v2 offset:256
    ds_read_b128 v[120:123], v2 offset:512
    ds_read_b128 v[124:127], v2 offset:768
    s_waitcnt vmcnt(14) lgkmcnt(8)
    v_mfma_f32_16x16x32_bf16 v[36:39], v[68:71], v[4:7], v[36:39]
    v_mfma_f32_16x16x32_bf16 v[40:43], v[68:71], v[8:11], v[40:43]
    v_mfma_f32_16x16x32_bf16 v[44:47], v[68:71], v[12:15], v[44:47]
    v_mfma_f32_16x16x32_bf16 v[48:51], v[68:71], v[16:19], v[48:51]
    s_add_u32 s45, s45, 4096
    buffer_load_dwordx4 v[68:71], v1, s[12:15], s45 offen offset:0 sc1
    ds_read_b128 v[4:7], v2 offset:4096
    ds_read_b128 v[8:11], v2 offset:4352
    ds_read_b128 v[12:15], v2 offset:4608
    ds_read_b128 v[16:19], v2 offset:4864
    s_waitcnt vmcnt(14) lgkmcnt(8)
    v_mfma_f32_16x16x32_bf16 v[36:39], v[72:75], v[20:23], v[36:39]
    v_mfma_f32_16x16x32_bf16 v[40:43], v[72:75], v[24:27], v[40:43]
    v_mfma_f32_16x16x32_bf16 v[44:47], v[72:75], v[28:31], v[44:47]
    v_mfma_f32_16x16x32_bf16 v[48:51], v[72:75], v[32:35], v[48:51]
    buffer_load_dwordx4 v[72:75], v1, s[12:15], s45 offen offset:1024 sc1
    ds_read_b128 v[20:23], v2 offset:8192
    ds_read_b128 v[24:27], v2 offset:8448
    ds_read_b128 v[28:31], v2 offset:8704
    ds_read_b128 v[32:35], v2 offset:8960
    s_waitcnt vmcnt(14) lgkmcnt(8)
    v_mfma_f32_16x16x32_bf16 v[36:39], v[76:79], v[112:115], v[36:39]
    v_mfma_f32_16x16x32_bf16 v[40:43], v[76:79], v[116:119], v[40:43]
    v_mfma_f32_16x16x32_bf16 v[44:47], v[76:79], v[120:123], v[44:47]
    v_mfma_f32_16x16x32_bf16 v[48:51], v[76:79], v[124:127], v[48:51]
    buffer_load_dwordx4 v[76:79], v1, s[12:15], s45 offen offset:2048 sc1
    ds_read_b128 v[112:115], v2 offset:12288
    ds_read_b128 v[116:119], v2 offset:12544
    ds_read_b128 v[120:123], v2 offset:12800
    ds_read_b128 v[124:127], v2 offset:13056
    s_waitcnt vmcnt(14) lgkmcnt(8)
    v_mfma_f32_16x16x32_bf16 v[36:39], v[80:83], v[4:7], v[36:39]
    v_mfma_f32_16x16x32_bf16 v[40:43], v[80:83], v[8:11], v[40:43]
    v_mfma_f32_16x16x32_bf16 v[44:47], v[80:83], v[12:15], v[44:47]
    v_mfma_f32_16x16x32_bf16 v[48:51], v[80:83], v[16:19], v[48:51]
    buffer_load_dwordx4 v[80:83], v1, s[12:15], s45 offen offset:3072 sc1
    ds_read_b128 v[4:7], v2 offset:16384
    ds_read_b128 v[8:11], v2 offset:16640
    ds_read_b128 v[12:15], v2 offset:16896
    ds_read_b128 v[16:19], v2 offset:17152
    s_waitcnt vmcnt(14) lgkmcnt(8)
    v_mfma_f32_16x16x32_bf16 v[36:39], v[84:87], v[20:23], v[36:39]
    v_mfma_f32_16x16x32_bf16 v[40:43], v[84:87], v[24:27], v[40:43]
    v_mfma_f32_16x16x32_bf16 v[44:47], v[84:87], v[28:31], v[44:47]
    v_mfma_f32_16x16x32_bf16 v[48:51], v[84:87], v[32:35], v[48:51]
    s_add_u32 s45, s45, 4096
    buffer_load_dwordx4 v[84:87], v1, s[12:15], s45 offen offset:0 sc1
    ds_read_b128 v[20:23], v2 offset:20480
    ds_read_b128 v[24:27], v2 offset:20736
    ds_read_b128 v[28:31], v2 offset:20992
    ds_read_b128 v[32:35], v2 offset:21248
    s_waitcnt vmcnt(14) lgkmcnt(8)
    v_mfma_f32_16x16x32_bf16 v[36:39], v[88:91], v[112:115], v[36:39]
    v_mfma_f32_16x16x32_bf16 v[40:43], v[88:91], v[116:119], v[40:43]
    v_mfma_f32_16x16x32_bf16 v[44:47], v[88:91], v[120:123], v[44:47]
    v_mfma_f32_16x16x32_bf16 v[48:51], v[88:91], v[124:127], v[48:51]
    buffer_load_dwordx4 v[88:91], v1, s[12:15], s45 offen offset:1024 sc1
    ds_read_b128 v[112:115], v2 offset:24576
    ds_read_b128 v[116:119], v2 offset:24832
    ds_read_b128 v[120:123], v2 offset:25088
    ds_read_b128 v[124:127], v2 offset:25344
    s_waitcnt vmcnt(14) lgkmcnt(8)
    v_mfma_f32_16x16x32_bf16 v[36:39], v[92:95], v[4:7], v[36:39]
    v_mfma_f32_16x16x32_bf16 v[40:43], v[92:95], v[8:11], v[40:43]
    v_mfma_f32_16x16x32_bf16 v[44:47], v[92:95], v[12:15], v[44:47]
    v_mfma_f32_16x16x32_bf16 v[48:51], v[92:95], v[16:19], v[48:51]
    buffer_load_dwordx4 v[92:95], v1, s[12:15], s45 offen offset:2048 sc1
    ds_read_b128 v[4:7], v2 offset:28672
    ds_read_b128 v[8:11], v2 offset:28928
    ds_read_b128 v[12:15], v2 offset:29184
    ds_read_b128 v[16:19], v2 offset:29440
    s_waitcnt vmcnt(14) lgkmcnt(8)
    v_mfma_f32_16x16x32_bf16 v[36:39], v[96:99], v[20:23], v[36:39]
    v_mfma_f32_16x16x32_bf16 v[40:43], v[96:99], v[24:27], v[40:43]
    v_mfma_f32_16x16x32_bf16 v[44:47], v[96:99], v[28:31], v[44:47]
    v_mfma_f32_16x16x32_bf16 v[48:51], v[96:99], v[32:35], v[48:51]
    buffer_load_dwordx4 v[96:99], v1, s[12:15], s45 offen offset:3072 sc1
    ds_read_b128 v[20:23], v2 offset:32768
    ds_read_b128 v[24:27], v2 offset:33024
    ds_read_b128 v[28:31], v2 offset:33280
    ds_read_b128 v[32:35], v2 offset:33536
    s_waitcnt vmcnt(14) lgkmcnt(8)
    v_mfma_f32_16x16x32_bf16 v[36:39], v[100:103], v[112:115], v[36:39]
    v_mfma_f32_16x16x32_bf16 v[40:43], v[100:103], v[116:119], v[40:43]
    v_mfma_f32_16x16x32_bf16 v[44:47], v[100:103], v[120:123], v[44:47]
    v_mfma_f32_16x16x32_bf16 v[48:51], v[100:103], v[124:127], v[48:51]
    s_add_u32 s45, s45, 4096
    buffer_load_dwordx4 v[100:103], v1, s[12:15], s45 offen offset:0 sc1
    ds_read_b128 v[112:115], v0 offset:0
    ds_read_b128 v[116:119], v0 offset:256
    ds_read_b128 v[120:123], v0 offset:512
    ds_read_b128 v[124:127], v0 offset:768
    s_waitcnt vmcnt(14) lgkmcnt(8)
    v_mfma_f32_16x16x32_bf16 v[36:39], v[104:107], v[4:7], v[36:39]
    v_mfma_f32_16x16x32_bf16 v[40:43], v[104:107], v[8:11], v[40:43]
    v_mfma_f32_16x16x32_bf16 v[44:47], v[104:107], v[12:15], v[44:47]
    v_mfma_f32_16x16x32_bf16 v[48:51], v[104:107], v[16:19], v[48:51]
    buffer_load_dwordx4 v[104:107], v1, s[12:15], s45 offen offset:1024 sc1
    ds_read_b128 v[4:7], v0 offset:4096
    ds_read_b128 v[8:11], v0 offset:4352
    ds_read_b128 v[12:15], v0 offset:4608
    ds_read_b128 v[16:19], v0 offset:4864
    s_waitcnt vmcnt(14) lgkmcnt(8)
    v_mfma_f32_16x16x32_bf16 v[36:39], v[108:111], v[20:23], v[36:39]
    v_mfma_f32_16x16x32_bf16 v[40:43], v[108:111], v[24:27], v[40:43]
    v_mfma_f32_16x16x32_bf16 v[44:47], v[108:111], v[28:31], v[44:47]
    v_mfma_f32_16x16x32_bf16 v[48:51], v[108:111], v[32:35], v[48:51]
    buffer_load_dwordx4 v[108:111], v1, s[12:15], s45 offen offset:2048 sc1
    s_nop 7
    v_cvt_pk_bf16_f32 v36, v36, v37
    v_cvt_pk_bf16_f32 v37, v38, v39
    v_cvt_pk_bf16_f32 v38, v40, v41
    v_cvt_pk_bf16_f32 v39, v42, v43
    buffer_store_dwordx4 v[36:39], v1, s[12:15], s50 offen offset:0 sc1
    v_cvt_pk_bf16_f32 v44, v44, v45
    v_cvt_pk_bf16_f32 v45, v46, v47
    v_cvt_pk_bf16_f32 v46, v48, v49
    v_cvt_pk_bf16_f32 v47, v50, v51
    buffer_store_dwordx4 v[44:47], v1, s[12:15], s51 offen offset:0 sc1
    s_setprio 1
    s_nop 1
    ds_read_b128 v[20:23], v0 offset:8192
    ds_read_b128 v[24:27], v0 offset:8448
    ds_read_b128 v[28:31], v0 offset:8704
    ds_read_b128 v[32:35], v0 offset:8960
    s_waitcnt vmcnt(16) lgkmcnt(8)
    v_mfma_f32_16x16x32_bf16 v[36:39], v[52:55], v[112:115], 0
    v_mfma_f32_16x16x32_bf16 v[40:43], v[52:55], v[116:119], 0
    v_mfma_f32_16x16x32_bf16 v[44:47], v[52:55], v[120:123], 0
    v_mfma_f32_16x16x32_bf16 v[48:51], v[52:55], v[124:127], 0
    buffer_load_dwordx4 v[52:55], v1, s[12:15], s45 offen offset:3072 sc1
    ds_read_b128 v[112:115], v0 offset:12288
    ds_read_b128 v[116:119], v0 offset:12544
    ds_read_b128 v[120:123], v0 offset:12800
    ds_read_b128 v[124:127], v0 offset:13056
    s_waitcnt vmcnt(16) lgkmcnt(8)
    v_mfma_f32_16x16x32_bf16 v[36:39], v[56:59], v[4:7], v[36:39]
    v_mfma_f32_16x16x32_bf16 v[40:43], v[56:59], v[8:11], v[40:43]
    v_mfma_f32_16x16x32_bf16 v[44:47], v[56:59], v[12:15], v[44:47]
    v_mfma_f32_16x16x32_bf16 v[48:51], v[56:59], v[16:19], v[48:51]
    s_add_u32 s45, s45, 4096
    buffer_load_dwordx4 v[56:59], v1, s[12:15], s45 offen offset:0 sc1
    ds_read_b128 v[4:7], v0 offset:16384
    ds_read_b128 v[8:11], v0 offset:16640
    ds_read_b128 v[12:15], v0 offset:16896
    ds_read_b128 v[16:19], v0 offset:17152
    s_waitcnt vmcnt(16) lgkmcnt(8)
    v_mfma_f32_16x16x32_bf16 v[36:39], v[60:63], v[20:23], v[36:39]
    v_mfma_f32_16x16x32_bf16 v[40:43], v[60:63], v[24:27], v[40:43]
    v_mfma_f32_16x16x32_bf16 v[44:47], v[60:63], v[28:31], v[44:47]
    v_mfma_f32_16x16x32_bf16 v[48:51], v[60:63], v[32:35], v[48:51]
    buffer_load_dwordx4 v[60:63], v1, s[12:15], s45 offen offset:1024 sc1
    ds_read_b128 v[20:23], v0 offset:20480
    ds_read_b128 v[24:27], v0 offset:20736
    ds_read_b128 v[28:31], v0 offset:20992
    ds_read_b128 v[32:35], v0 offset:21248
    s_waitcnt vmcnt(16) lgkmcnt(8)
    v_mfma_f32_16x16x32_bf16 v[36:39], v[64:67], v[112:115], v[36:39]
    v_mfma_f32_16x16x32_bf16 v[40:43], v[64:67], v[116:119], v[40:43]
    v_mfma_f32_16x16x32_bf16 v[44:47], v[64:67], v[120:123], v[44:47]
    v_mfma_f32_16x16x32_bf16 v[48:51], v[64:67], v[124:127], v[48:51]
    buffer_load_dwordx4 v[64:67], v1, s[12:15], s46 offen offset:0 sc1
    ds_read_b128 v[112:115], v0 offset:24576
    ds_read_b128 v[116:119], v0 offset:24832
    ds_read_b128 v[120:123], v0 offset:25088
    ds_read_b128 v[124:127], v0 offset:25344
    s_waitcnt vmcnt(16) lgkmcnt(8)
    v_mfma_f32_16x16x32_bf16 v[36:39], v[68:71], v[4:7], v[36:39]
    v_mfma_f32_16x16x32_bf16 v[40:43], v[68:71], v[8:11], v[40:43]
    v_mfma_f32_16x16x32_bf16 v[44:47], v[68:71], v[12:15], v[44:47]
    v_mfma_f32_16x16x32_bf16 v[48:51], v[68:71], v[16:19], v[48:51]
    buffer_load_dwordx4 v[68:71], v1, s[12:15], s46 offen offset:1024 sc1
    s_waitcnt vmcnt(5)
    v_mov_b32 v3, 163328
    v_mov_b32 v4, 1
    s_mov_b64 exec, 1
    ds_add_u32 v3, v4
    s_mov_b64 exec, -1
    ds_read_b128 v[4:7], v0 offset:28672
    ds_read_b128 v[8:11], v0 offset:28928
    ds_read_b128 v[12:15], v0 offset:29184
    ds_read_b128 v[16:19], v0 offset:29440
    s_waitcnt vmcnt(16) lgkmcnt(8)
    v_mfma_f32_16x16x32_bf16 v[36:39], v[72:75], v[20:23], v[36:39]
    v_mfma_f32_16x16x32_bf16 v[40:43], v[72:75], v[24:27], v[40:43]
    v_mfma_f32_16x16x32_bf16 v[44:47], v[72:75], v[28:31], v[44:47]
    v_mfma_f32_16x16x32_bf16 v[48:51], v[72:75], v[32:35], v[48:51]
    buffer_load_dwordx4 v[72:75], v1, s[12:15], s46 offen offset:2048 sc1
    ds_read_b128 v[20:23], v0 offset:32768
    ds_read_b128 v[24:27], v0 offset:33024
    ds_read_b128 v[28:31], v0 offset:33280
    ds_read_b128 v[32:35], v0 offset:33536
    s_waitcnt vmcnt(16) lgkmcnt(8)
    v_mfma_f32_16x16x32_bf16 v[36:39], v[76:79], v[112:115], v[36:39]
    v_mfma_f32_16x16x32_bf16 v[40:43], v[76:79], v[116:119], v[40:43]
    v_mfma_f32_16x16x32_bf16 v[44:47], v[76:79], v[120:123], v[44:47]
    v_mfma_f32_16x16x32_bf16 v[48:51], v[76:79], v[124:127], v[48:51]
    buffer_load_dwordx4 v[76:79], v1, s[12:15], s46 offen offset:3072 sc1
    ds_read_b128 v[112:115], v2 offset:0
    ds_read_b128 v[116:119], v2 offset:256
    ds_read_b128 v[120:123], v2 offset:512
    ds_read_b128 v[124:127], v2 offset:768
    s_waitcnt vmcnt(16) lgkmcnt(8)
    v_mfma_f32_16x16x32_bf16 v[36:39], v[80:83], v[4:7], v[36:39]
    v_mfma_f32_16x16x32_bf16 v[40:43], v[80:83], v[8:11], v[40:43]
    v_mfma_f32_16x16x32_bf16 v[44:47], v[80:83], v[12:15], v[44:47]
    v_mfma_f32_16x16x32_bf16 v[48:51], v[80:83], v[16:19], v[48:51]
    s_add_u32 s46, s46, 4096
    buffer_load_dwordx4 v[80:83], v1, s[12:15], s46 offen offset:0 sc1
    ds_read_b128 v[4:7], v2 offset:4096
    ds_read_b128 v[8:11], v2 offset:4352
    ds_read_b128 v[12:15], v2 offset:4608
    ds_read_b128 v[16:19], v2 offset:4864
    s_waitcnt vmcnt(16) lgkmcnt(8)
    v_mfma_f32_16x16x32_bf16 v[36:39], v[84:87], v[20:23], v[36:39]
    v_mfma_f32_16x16x32_bf16 v[40:43], v[84:87], v[24:27], v[40:43]
    v_mfma_f32_16x16x32_bf16 v[44:47], v[84:87], v[28:31], v[44:47]
    v_mfma_f32_16x16x32_bf16 v[48:51], v[84:87], v[32:35], v[48:51]
    buffer_load_dwordx4 v[84:87], v1, s[12:15], s46 offen offset:1024 sc1
    ds_read_b128 v[20:23], v2 offset:8192
    ds_read_b128 v[24:27], v2 offset:8448
    ds_read_b128 v[28:31], v2 offset:8704
    ds_read_b128 v[32:35], v2 offset:8960
    s_waitcnt vmcnt(16) lgkmcnt(8)
    v_mfma_f32_16x16x32_bf16 v[36:39], v[88:91], v[112:115], v[36:39]
    v_mfma_f32_16x16x32_bf16 v[40:43], v[88:91], v[116:119], v[40:43]
    v_mfma_f32_16x16x32_bf16 v[44:47], v[88:91], v[120:123], v[44:47]
    v_mfma_f32_16x16x32_bf16 v[48:51], v[88:91], v[124:127], v[48:51]
    buffer_load_dwordx4 v[88:91], v1, s[12:15], s46 offen offset:2048 sc1
    ds_read_b128 v[112:115], v2 offset:12288
    ds_read_b128 v[116:119], v2 offset:12544
    ds_read_b128 v[120:123], v2 offset:12800
    ds_read_b128 v[124:127], v2 offset:13056
    s_waitcnt vmcnt(16) lgkmcnt(8)
    v_mfma_f32_16x16x32_bf16 v[36:39], v[92:95], v[4:7], v[36:39]
    v_mfma_f32_16x16x32_bf16 v[40:43], v[92:95], v[8:11], v[40:43]
    v_mfma_f32_16x16x32_bf16 v[44:47], v[92:95], v[12:15], v[44:47]
    v_mfma_f32_16x16x32_bf16 v[48:51], v[92:95], v[16:19], v[48:51]
    buffer_load_dwordx4 v[92:95], v1, s[12:15], s46 offen offset:3072 sc1
    ds_read_b128 v[4:7], v2 offset:16384
    ds_read_b128 v[8:11], v2 offset:16640
    ds_read_b128 v[12:15], v2 offset:16896
    ds_read_b128 v[16:19], v2 offset:17152
    s_waitcnt vmcnt(16) lgkmcnt(8)
    v_mfma_f32_16x16x32_bf16 v[36:39], v[96:99], v[20:23], v[36:39]
    v_mfma_f32_16x16x32_bf16 v[40:43], v[96:99], v[24:27], v[40:43]
    v_mfma_f32_16x16x32_bf16 v[44:47], v[96:99], v[28:31], v[44:47]
    v_mfma_f32_16x16x32_bf16 v[48:51], v[96:99], v[32:35], v[48:51]
    s_add_u32 s46, s46, 4096
    buffer_load_dwordx4 v[96:99], v1, s[12:15], s46 offen offset:0 sc1
    ds_read_b128 v[20:23], v2 offset:20480
    ds_read_b128 v[24:27], v2 offset:20736
    ds_read_b128 v[28:31], v2 offset:20992
    ds_read_b128 v[32:35], v2 offset:21248
    s_waitcnt vmcnt(16) lgkmcnt(8)
    v_mfma_f32_16x16x32_bf16 v[36:39], v[100:103], v[112:115], v[36:39]
    v_mfma_f32_16x16x32_bf16 v[40:43], v[100:103], v[116:119], v[40:43]
    v_mfma_f32_16x16x32_bf16 v[44:47], v[100:103], v[120:123], v[44:47]
    v_mfma_f32_16x16x32_bf16 v[48:51], v[100:103], v[124:127], v[48:51]
    buffer_load_dwordx4 v[100:103], v1, s[12:15], s46 offen offset:1024 sc1
    ds_read_b128 v[112:115], v2 offset:24576
    ds_read_b128 v[116:119], v2 offset:24832
    ds_read_b128 v[120:123], v2 offset:25088
    ds_read_b128 v[124:127], v2 offset:25344
    s_waitcnt vmcnt(16) lgkmcnt(8)
    v_mfma_f32_16x16x32_bf16 v[36:39], v[104:107], v[4:7], v[36:39]
    v_mfma_f32_16x16x32_bf16 v[40:43], v[104:107], v[8:11], v[40:43]
    v_mfma_f32_16x16x32_bf16 v[44:47], v[104:107], v[12:15], v[44:47]
    v_mfma_f32_16x16x32_bf16 v[48:51], v[104:107], v[16:19], v[48:51]
    buffer_load_dwordx4 v[104:107], v1, s[12:15], s46 offen offset:2048 sc1
    ds_read_b128 v[4:7], v2 offset:28672
    ds_read_b128 v[8:11], v2 offset:28928
    ds_read_b128 v[12:15], v2 offset:29184
    ds_read_b128 v[16:19], v2 offset:29440
    s_waitcnt vmcnt(16) lgkmcnt(8)
    v_mfma_f32_16x16x32_bf16 v[36:39], v[108:111], v[20:23], v[36:39]
    v_mfma_f32_16x16x32_bf16 v[40:43], v[108:111], v[24:27], v[40:43]
    v_mfma_f32_16x16x32_bf16 v[44:47], v[108:111], v[28:31], v[44:47]
    v_mfma_f32_16x16x32_bf16 v[48:51], v[108:111], v[32:35], v[48:51]
    buffer_load_dwordx4 v[108:111], v1, s[12:15], s46 offen offset:3072 sc1
    ds_read_b128 v[20:23], v2 offset:32768
    ds_read_b128 v[24:27], v2 offset:33024
    ds_read_b128 v[28:31], v2 offset:33280
    ds_read_b128 v[32:35], v2 offset:33536
    s_waitcnt vmcnt(14) lgkmcnt(8)
    v_mfma_f32_16x16x32_bf16 v[36:39], v[52:55], v[112:115], v[36:39]
    v_mfma_f32_16x16x32_bf16 v[40:43], v[52:55], v[116:119], v[40:43]
    v_mfma_f32_16x16x32_bf16 v[44:47], v[52:55], v[120:123], v[44:47]
    v_mfma_f32_16x16x32_bf16 v[48:51], v[52:55], v[124:127], v[48:51]
    s_add_u32 s46, s46, 4096
    buffer_load_dwordx4 v[52:55], v1, s[12:15], s46 offen offset:0 sc1
    ds_read_b128 v[112:115], v0 offset:0
    ds_read_b128 v[116:119], v0 offset:256
    ds_read_b128 v[120:123], v0 offset:512
    ds_read_b128 v[124:127], v0 offset:768
    s_waitcnt vmcnt(14) lgkmcnt(8)
    v_mfma_f32_16x16x32_bf16 v[36:39], v[56:59], v[4:7], v[36:39]
    v_mfma_f32_16x16x32_bf16 v[40:43], v[56:59], v[8:11], v[40:43]
    v_mfma_f32_16x16x32_bf16 v[44:47], v[56:59], v[12:15], v[44:47]
    v_mfma_f32_16x16x32_bf16 v[48:51], v[56:59], v[16:19], v[48:51]
    buffer_load_dwordx4 v[56:59], v1, s[12:15], s46 offen offset:1024 sc1
    ds_read_b128 v[4:7], v0 offset:4096
    ds_read_b128 v[8:11], v0 offset:4352
    ds_read_b128 v[12:15], v0 offset:4608
    ds_read_b128 v[16:19], v0 offset:4864
    s_waitcnt vmcnt(14) lgkmcnt(8)
    v_mfma_f32_16x16x32_bf16 v[36:39], v[60:63], v[20:23], v[36:39]
    v_mfma_f32_16x16x32_bf16 v[40:43], v[60:63], v[24:27], v[40:43]
    v_mfma_f32_16x16x32_bf16 v[44:47], v[60:63], v[28:31], v[44:47]
    v_mfma_f32_16x16x32_bf16 v[48:51], v[60:63], v[32:35], v[48:51]
    buffer_load_dwordx4 v[60:63], v1, s[12:15], s46 offen offset:2048 sc1
    s_nop 7
    v_cvt_pk_bf16_f32 v36, v36, v37
    v_cvt_pk_bf16_f32 v37, v38, v39
    v_cvt_pk_bf16_f32 v38, v40, v41
    v_cvt_pk_bf16_f32 v39, v42, v43
    buffer_store_dwordx4 v[36:39], v1, s[12:15], s50 offen offset:1024 sc1
    v_cvt_pk_bf16_f32 v44, v44, v45
    v_cvt_pk_bf16_f32 v45, v46, v47
    v_cvt_pk_bf16_f32 v46, v48, v49
    v_cvt_pk_bf16_f32 v47, v50, v51
    buffer_store_dwordx4 v[44:47], v1, s[12:15], s51 offen offset:1024 sc1
    s_setprio 0
    s_nop 1
    ds_read_b128 v[20:23], v0 offset:8192
    ds_read_b128 v[24:27], v0 offset:8448
    ds_read_b128 v[28:31], v0 offset:8704
    ds_read_b128 v[32:35], v0 offset:8960
    s_waitcnt vmcnt(16) lgkmcnt(8)
    v_mfma_f32_16x16x32_bf16 v[36:39], v[64:67], v[112:115], 0
    v_mfma_f32_16x16x32_bf16 v[40:43], v[64:67], v[116:119], 0
    v_mfma_f32_16x16x32_bf16 v[44:47], v[64:67], v[120:123], 0
    v_mfma_f32_16x16x32_bf16 v[48:51], v[64:67], v[124:127], 0
    buffer_load_dwordx4 v[64:67], v1, s[12:15], s46 offen offset:3072 sc1
    ds_read_b128 v[112:115], v0 offset:12288
    ds_read_b128 v[116:119], v0 offset:12544
    ds_read_b128 v[120:123], v0 offset:12800
    ds_read_b128 v[124:127], v0 offset:13056
    s_waitcnt vmcnt(16) lgkmcnt(8)
    v_mfma_f32_16x16x32_bf16 v[36:39], v[68:71], v[4:7], v[36:39]
    v_mfma_f32_16x16x32_bf16 v[40:43], v[68:71], v[8:11], v[40:43]
    v_mfma_f32_16x16x32_bf16 v[44:47], v[68:71], v[12:15], v[44:47]
    v_mfma_f32_16x16x32_bf16 v[48:51], v[68:71], v[16:19], v[48:51]
    s_add_u32 s46, s46, 4096
    buffer_load_dwordx4 v[68:71], v1, s[12:15], s46 offen offset:0 sc1
    ds_read_b128 v[4:7], v0 offset:16384
    ds_read_b128 v[8:11], v0 offset:16640
    ds_read_b128 v[12:15], v0 offset:16896
    ds_read_b128 v[16:19], v0 offset:17152
    s_waitcnt vmcnt(16) lgkmcnt(8)
    v_mfma_f32_16x16x32_bf16 v[36:39], v[72:75], v[20:23], v[36:39]
    v_mfma_f32_16x16x32_bf16 v[40:43], v[72:75], v[24:27], v[40:43]
    v_mfma_f32_16x16x32_bf16 v[44:47], v[72:75], v[28:31], v[44:47]
    v_mfma_f32_16x16x32_bf16 v[48:51], v[72:75], v[32:35], v[48:51]
    buffer_load_dwordx4 v[72:75], v1, s[12:15], s46 offen offset:1024 sc1
    ds_read_b128 v[20:23], v0 offset:20480
    ds_read_b128 v[24:27], v0 offset:20736
    ds_read_b128 v[28:31], v0 offset:20992
    ds_read_b128 v[32:35], v0 offset:21248
    s_waitcnt vmcnt(16) lgkmcnt(8)
    v_mfma_f32_16x16x32_bf16 v[36:39], v[76:79], v[112:115], v[36:39]
    v_mfma_f32_16x16x32_bf16 v[40:43], v[76:79], v[116:119], v[40:43]
    v_mfma_f32_16x16x32_bf16 v[44:47], v[76:79], v[120:123], v[44:47]
    v_mfma_f32_16x16x32_bf16 v[48:51], v[76:79], v[124:127], v[48:51]
    ds_read_b128 v[112:115], v0 offset:24576
    ds_read_b128 v[116:119], v0 offset:24832
    ds_read_b128 v[120:123], v0 offset:25088
    ds_read_b128 v[124:127], v0 offset:25344
    s_waitcnt vmcnt(15) lgkmcnt(8)
    v_mfma_f32_16x16x32_bf16 v[36:39], v[80:83], v[4:7], v[36:39]
    v_mfma_f32_16x16x32_bf16 v[40:43], v[80:83], v[8:11], v[40:43]
    v_mfma_f32_16x16x32_bf16 v[44:47], v[80:83], v[12:15], v[44:47]
    v_mfma_f32_16x16x32_bf16 v[48:51], v[80:83], v[16:19], v[48:51]
    s_waitcnt vmcnt(3)
    v_mov_b32 v3, 163332
    v_mov_b32 v4, 1
    s_mov_b64 exec, 1
    ds_add_u32 v3, v4
    s_mov_b64 exec, -1
    ds_read_b128 v[4:7], v0 offset:28672
    ds_read_b128 v[8:11], v0 offset:28928
    ds_read_b128 v[12:15], v0 offset:29184
    ds_read_b128 v[16:19], v0 offset:29440
    s_waitcnt vmcnt(14) lgkmcnt(8)
    v_mfma_f32_16x16x32_bf16 v[36:39], v[84:87], v[20:23], v[36:39]
    v_mfma_f32_16x16x32_bf16 v[40:43], v[84:87], v[24:27], v[40:43]
    v_mfma_f32_16x16x32_bf16 v[44:47], v[84:87], v[28:31], v[44:47]
    v_mfma_f32_16x16x32_bf16 v[48:51], v[84:87], v[32:35], v[48:51]
    ds_read_b128 v[20:23], v0 offset:32768
    ds_read_b128 v[24:27], v0 offset:33024
    ds_read_b128 v[28:31], v0 offset:33280
    ds_read_b128 v[32:35], v0 offset:33536
    s_waitcnt vmcnt(13) lgkmcnt(8)
    v_mfma_f32_16x16x32_bf16 v[36:39], v[88:91], v[112:115], v[36:39]
    v_mfma_f32_16x16x32_bf16 v[40:43], v[88:91], v[116:119], v[40:43]
    v_mfma_f32_16x16x32_bf16 v[44:47], v[88:91], v[120:123], v[44:47]
    v_mfma_f32_16x16x32_bf16 v[48:51], v[88:91], v[124:127], v[48:51]
    ds_read_b128 v[112:115], v2 offset:0
    ds_read_b128 v[116:119], v2 offset:256
    ds_read_b128 v[120:123], v2 offset:512
    ds_read_b128 v[124:127], v2 offset:768
    s_waitcnt vmcnt(12) lgkmcnt(8)
    v_mfma_f32_16x16x32_bf16 v[36:39], v[92:95], v[4:7], v[36:39]
    v_mfma_f32_16x16x32_bf16 v[40:43], v[92:95], v[8:11], v[40:43]
    v_mfma_f32_16x16x32_bf16 v[44:47], v[92:95], v[12:15], v[44:47]
    v_mfma_f32_16x16x32_bf16 v[48:51], v[92:95], v[16:19], v[48:51]
    ds_read_b128 v[4:7], v2 offset:4096
    ds_read_b128 v[8:11], v2 offset:4352
    ds_read_b128 v[12:15], v2 offset:4608
    ds_read_b128 v[16:19], v2 offset:4864
    s_waitcnt vmcnt(11) lgkmcnt(8)
    v_mfma_f32_16x16x32_bf16 v[36:39], v[96:99], v[20:23], v[36:39]
    v_mfma_f32_16x16x32_bf16 v[40:43], v[96:99], v[24:27], v[40:43]
    v_mfma_f32_16x16x32_bf16 v[44:47], v[96:99], v[28:31], v[44:47]
    v_mfma_f32_16x16x32_bf16 v[48:51], v[96:99], v[32:35], v[48:51]
    ds_read_b128 v[20:23], v2 offset:8192
    ds_read_b128 v[24:27], v2 offset:8448
    ds_read_b128 v[28:31], v2 offset:8704
    ds_read_b128 v[32:35], v2 offset:8960
    s_waitcnt vmcnt(10) lgkmcnt(8)
    v_mfma_f32_16x16x32_bf16 v[36:39], v[100:103], v[112:115], v[36:39]
    v_mfma_f32_16x16x32_bf16 v[40:43], v[100:103], v[116:119], v[40:43]
    v_mfma_f32_16x16x32_bf16 v[44:47], v[100:103], v[120:123], v[44:47]
    v_mfma_f32_16x16x32_bf16 v[48:51], v[100:103], v[124:127], v[48:51]
    ds_read_b128 v[112:115], v2 offset:12288
    ds_read_b128 v[116:119], v2 offset:12544
    ds_read_b128 v[120:123], v2 offset:12800
    ds_read_b128 v[124:127], v2 offset:13056
    s_waitcnt vmcnt(9) lgkmcnt(8)
    v_mfma_f32_16x16x32_bf16 v[36:39], v[104:107], v[4:7], v[36:39]
    v_mfma_f32_16x16x32_bf16 v[40:43], v[104:107], v[8:11], v[40:43]
    v_mfma_f32_16x16x32_bf16 v[44:47], v[104:107], v[12:15], v[44:47]
    v_mfma_f32_16x16x32_bf16 v[48:51], v[104:107], v[16:19], v[48:51]
    ds_read_b128 v[4:7], v2 offset:16384
    ds_read_b128 v[8:11], v2 offset:16640
    ds_read_b128 v[12:15], v2 offset:16896
    ds_read_b128 v[16:19], v2 offset:17152
    s_waitcnt vmcnt(8) lgkmcnt(8)
    v_mfma_f32_16x16x32_bf16 v[36:39], v[108:111], v[20:23], v[36:39]
    v_mfma_f32_16x16x32_bf16 v[40:43], v[108:111], v[24:27], v[40:43]
    v_mfma_f32_16x16x32_bf16 v[44:47], v[108:111], v[28:31], v[44:47]
    v_mfma_f32_16x16x32_bf16 v[48:51], v[108:111], v[32:35], v[48:51]
    ds_read_b128 v[20:23], v2 offset:20480
    ds_read_b128 v[24:27], v2 offset:20736
    ds_read_b128 v[28:31], v2 offset:20992
    ds_read_b128 v[32:35], v2 offset:21248
    s_waitcnt vmcnt(7) lgkmcnt(8)
    v_mfma_f32_16x16x32_bf16 v[36:39], v[52:55], v[112:115], v[36:39]
    v_mfma_f32_16x16x32_bf16 v[40:43], v[52:55], v[116:119], v[40:43]
    v_mfma_f32_16x16x32_bf16 v[44:47], v[52:55], v[120:123], v[44:47]
    v_mfma_f32_16x16x32_bf16 v[48:51], v[52:55], v[124:127], v[48:51]
    ds_read_b128 v[112:115], v2 offset:24576
    ds_read_b128 v[116:119], v2 offset:24832
    ds_read_b128 v[120:123], v2 offset:25088
    ds_read_b128 v[124:127], v2 offset:25344
    s_waitcnt vmcnt(6) lgkmcnt(8)
    v_mfma_f32_16x16x32_bf16 v[36:39], v[56:59], v[4:7], v[36:39]
    v_mfma_f32_16x16x32_bf16 v[40:43], v[56:59], v[8:11], v[40:43]
    v_mfma_f32_16x16x32_bf16 v[44:47], v[56:59], v[12:15], v[44:47]
    v_mfma_f32_16x16x32_bf16 v[48:51], v[56:59], v[16:19], v[48:51]
    ds_read_b128 v[4:7], v2 offset:28672
    ds_read_b128 v[8:11], v2 offset:28928
    ds_read_b128 v[12:15], v2 offset:29184
    ds_read_b128 v[16:19], v2 offset:29440
    s_waitcnt vmcnt(5) lgkmcnt(8)
    v_mfma_f32_16x16x32_bf16 v[36:39], v[60:63], v[20:23], v[36:39]
    v_mfma_f32_16x16x32_bf16 v[40:43], v[60:63], v[24:27], v[40:43]
    v_mfma_f32_16x16x32_bf16 v[44:47], v[60:63], v[28:31], v[44:47]
    v_mfma_f32_16x16x32_bf16 v[48:51], v[60:63], v[32:35], v[48:51]
    ds_read_b128 v[20:23], v2 offset:32768
    ds_read_b128 v[24:27], v2 offset:33024
    ds_read_b128 v[28:31], v2 offset:33280
    ds_read_b128 v[32:35], v2 offset:33536
    s_waitcnt vmcnt(2) lgkmcnt(8)
    v_mfma_f32_16x16x32_bf16 v[36:39], v[64:67], v[112:115], v[36:39]
    v_mfma_f32_16x16x32_bf16 v[40:43], v[64:67], v[116:119], v[40:43]
    v_mfma_f32_16x16x32_bf16 v[44:47], v[64:67], v[120:123], v[44:47]
    v_mfma_f32_16x16x32_bf16 v[48:51], v[64:67], v[124:127], v[48:51]
    s_waitcnt vmcnt(1) lgkmcnt(4)
    v_mfma_f32_16x16x32_bf16 v[36:39], v[68:71], v[4:7], v[36:39]
    v_mfma_f32_16x16x32_bf16 v[40:43], v[68:71], v[8:11], v[40:43]
    v_mfma_f32_16x16x32_bf16 v[44:47], v[68:71], v[12:15], v[44:47]
    v_mfma_f32_16x16x32_bf16 v[48:51], v[68:71], v[16:19], v[48:51]
    s_waitcnt vmcnt(0) lgkmcnt(0)
    v_mfma_f32_16x16x32_bf16 v[36:39], v[72:75], v[20:23], v[36:39]
    v_mfma_f32_16x16x32_bf16 v[40:43], v[72:75], v[24:27], v[40:43]
    v_mfma_f32_16x16x32_bf16 v[44:47], v[72:75], v[28:31], v[44:47]
    v_mfma_f32_16x16x32_bf16 v[48:51], v[72:75], v[32:35], v[48:51]
    s_nop 7
    v_cvt_pk_bf16_f32 v36, v36, v37
    v_cvt_pk_bf16_f32 v37, v38, v39
    v_cvt_pk_bf16_f32 v38, v40, v41
    v_cvt_pk_bf16_f32 v39, v42, v43
    buffer_store_dwordx4 v[36:39], v1, s[12:15], s50 offen offset:2048 sc1
    v_cvt_pk_bf16_f32 v44, v44, v45
    v_cvt_pk_bf16_f32 v45, v46, v47
    v_cvt_pk_bf16_f32 v46, v48, v49
    v_cvt_pk_bf16_f32 v47, v50, v51
    buffer_store_dwordx4 v[44:47], v1, s[12:15], s51 offen offset:2048 sc1
    s_cmp_ge_u32 s6, 3
    s_cbranch_scc1 L_kb_end
    s_mul_i32 s52, s6, 3
    s_add_u32 s52, s52, 2
    s_mov_b32 s53, 9
    s_mov_b32 s54, 286720
    s_branch L_kb_red
L_kb_hwait:
    s_barrier
    s_mul_i32 s9, s23, 27
    v_add_u32 v5, s9, v2
    v_lshrrev_b32 v6, 2, v5
    v_and_b32 v5, 3, v5
    v_lshlrev_b32 v5, 2, v5
    v_lshl_add_u32 v6, v6, 7, v5
    v_lshlrev_b32 v5, 7, v2
    s_mov_b32 s10, 344064
    s_mov_b64 exec, 0x7ffffff
    s_mov_b32 s11, 262144
L_adaLN_cond__grouped_kv_mqa__dense_activation_relu__prompt_kernel_fs2m_6:
    buffer_load_dword v120, v6, s[12:15], s10 offen sc1
    s_waitcnt vmcnt(0)
    v_cmp_ne_u32 vcc, s3, v120
    s_cbranch_vccz L_adaLN_cond__grouped_kv_mqa__dense_activation_relu__prompt_kernel_fs2md_7
    s_sleep 4
    s_sub_u32 s11, s11, 1
    s_cmp_lg_u32 s11, 0
    s_cbranch_scc1 L_adaLN_cond__grouped_kv_mqa__dense_activation_relu__prompt_kernel_fs2m_6
L_adaLN_cond__grouped_kv_mqa__dense_activation_relu__prompt_kernel_fs2md_7:
    s_mov_b64 exec, -1
    s_mul_i32 s10, s23, 663552
    s_mul_i32 s11, s55, 41472
    s_add_u32 s10, s10, s11
    s_sub_u32 s11, s7, 1
    s_mul_i32 s11, s11, 13824
    s_add_u32 s10, s10, s11
    s_add_u32 s10, s10, 10485760
    s_add_u32 s10, s10, 6912
L_kb_hn2:
    s_barrier
    s_barrier
    s_barrier
    v_mov_b32 v8, -1
    v_mov_b32 v9, -1
    v_mov_b32 v10, -1
    v_mov_b32 v11, -1
    s_lshl_b32 s9, s22, 3
    s_lshl_b32 s10, s7, 1
    s_add_u32 s9, s9, s10
    s_lshl_b32 s9, s9, 3
    s_add_u32 s9, s9, s23
    s_mul_i32 s9, s9, 9216
    s_add_u32 s9, s9, 33556480
    buffer_store_dwordx4 v[8:11], v1, s[12:15], s9 offen sc1
    s_add_u32 s9, s9, 3072
    buffer_store_dwordx4 v[8:11], v1, s[12:15], s9 offen sc1
    s_add_u32 s9, s9, 3072
    buffer_store_dwordx4 v[8:11], v1, s[12:15], s9 offen sc1
    s_add_u32 s9, s9, 67584
    buffer_store_dwordx4 v[8:11], v1, s[12:15], s9 offen sc1
    s_add_u32 s9, s9, 3072
    buffer_store_dwordx4 v[8:11], v1, s[12:15], s9 offen sc1
    s_add_u32 s9, s9, 3072
    buffer_store_dwordx4 v[8:11], v1, s[12:15], s9 offen sc1
    s_add_u32 s9, s9, 67584
    s_barrier
    s_waitcnt vmcnt(0)
    s_barrier
    s_cmp_eq_u32 s6, 15
    s_cbranch_scc1 L_kb_pubw
    s_mul_i32 s52, s7, 3
    s_add_u32 s53, s52, 1
    s_mov_b32 s54, 286720
L_kb_red:
    v_lshrrev_b32 v2, 4, v1
    v_and_b32 v3, 15, v2
    v_lshrrev_b32 v4, 4, v2
    s_lshr_b32 s10, s2, 3
    s_lshl_b32 s10, s10, 7
    s_add_u32 s10, s10, s54
    v_lshlrev_b32 v5, 2, v2
    s_cmp_lt_u32 s6, 12
    s_cbranch_scc1 L_kb_gk
    s_cmp_eq_u32 s54, 286720
    s_cselect_b32 s9, 0, 4
    s_add_u32 s9, s9, 163328
    v_mov_b32 v8, s9
    s_mov_b32 s11, 262144
L_kb_gw:
    ds_read_b32 v9, v8
    s_waitcnt lgkmcnt(0)
    v_readfirstlane_b32 s9, v9
    s_cmp_ge_u32 s9, 12
    s_cbranch_scc1 L_kb_gs
    s_sleep 2
    s_sub_u32 s11, s11, 1
    s_cmp_lg_u32 s11, 0
    s_cbranch_scc1 L_kb_gw
L_kb_gs:
    s_sleep 4
L_kb_gk:
    s_mov_b64 exec, 255
    s_mov_b32 s11, 262144
L_adaLN_cond__grouped_kv_mqa__dense_activation_relu__prompt_kernel_f5_8:
    buffer_load_dword v120, v5, s[12:15], s10 offen sc1
    s_waitcnt vmcnt(0)
    v_cmp_ne_u32 vcc, s3, v120
    s_cbranch_vccz L_adaLN_cond__grouped_kv_mqa__dense_activation_relu__prompt_kernel_f5d_9
    s_sleep 3
    s_sub_u32 s11, s11, 1
    s_cmp_lg_u32 s11, 0
    s_cbranch_scc1 L_adaLN_cond__grouped_kv_mqa__dense_activation_relu__prompt_kernel_f5_8
L_adaLN_cond__grouped_kv_mqa__dense_activation_relu__prompt_kernel_f5d_9:
    s_mov_b64 exec, -1
    s_mov_b32 s16, s30
    s_mov_b32 s17, s31
    s_mov_b32 s18, 2359296
    s_mov_b32 s19, 0x20000
L_kb_red2:
    s_mul_i32 s36, s21, 9
    s_add_u32 s36, s36, s52
    s_lshl_b32 s9, s52, 10
    s_mul_i32 s10, s2, 73728
    s_add_u32 s10, s10, s9
    s_add_u32 s39, s10, 33554432
    s_cmp_ge_u32 s6, 3
    s_cbranch_scc1 L_kb_rld
    v_mul_u32_u24 v5, 9216, v2
    s_mov_b32 s11, 262144
    s_mov_b64 exec, 255
L_kb_rpr:
    buffer_load_dword v8, v5, s[12:15], s39 offen offset:1020 sc1
    s_waitcnt vmcnt(0)
    v_cmp_eq_u32 vcc, -1, v8
    s_cbranch_vccz L_kb_rpk
    s_sub_u32 s11, s11, 1
    s_cmp_lg_u32 s11, 0
    s_cbranch_scc1 L_kb_rpr
L_kb_rpk:
    s_mov_b64 exec, -1
    s_mov_b32 s11, 262144
L_kb_rld:
    s_mov_b32 s10, s39
    buffer_load_dwordx4 v[8:11], v1, s[12:15], s10 offen sc1
    s_add_u32 s10, s10, 9216
    buffer_load_dwordx4 v[12:15], v1, s[12:15], s10 offen sc1
    s_add_u32 s10, s10, 9216
    buffer_load_dwordx4 v[16:19], v1, s[12:15], s10 offen sc1
    s_add_u32 s10, s10, 9216
    buffer_load_dwordx4 v[20:23], v1, s[12:15], s10 offen sc1
    s_add_u32 s10, s10, 9216
    buffer_load_dwordx4 v[24:27], v1, s[12:15], s10 offen sc1
    s_add_u32 s10, s10, 9216
    buffer_load_dwordx4 v[28:31], v1, s[12:15], s10 offen sc1
    s_add_u32 s10, s10, 9216
    buffer_load_dwordx4 v[32:35], v1, s[12:15], s10 offen sc1
    s_add_u32 s10, s10, 9216
    buffer_load_dwordx4 v[36:39], v1, s[12:15], s10 offen sc1
    s_cmp_ge_u32 s6, 3
    s_cbranch_scc1 L_kb_rok
    s_waitcnt vmcnt(0)
    v_max_u32 v6, v8, v9
    v_max3_u32 v6, v6, v10, v11
    v_max3_u32 v6, v6, v12, v13
    v_max3_u32 v6, v6, v14, v15
    v_max3_u32 v6, v6, v16, v17
    v_max3_u32 v6, v6, v18, v19
    v_max3_u32 v6, v6, v20, v21
    v_max3_u32 v6, v6, v22, v23
    v_max3_u32 v6, v6, v24, v25
    v_max3_u32 v6, v6, v26, v27
    v_max3_u32 v6, v6, v28, v29
    v_max3_u32 v6, v6, v30, v31
    v_max3_u32 v6, v6, v32, v33
    v_max3_u32 v6, v6, v34, v35
    v_max3_u32 v6, v6, v36, v37
    v_max3_u32 v6, v6, v38, v39
    v_cmp_eq_u32 vcc, -1, v6
    s_cbranch_vccz L_kb_rok
    s_sub_u32 s11, s11, 1
    s_cmp_lg_u32 s11, 0
    s_cbranch_scc1 L_kb_rld
L_kb_rok:
    s_add_u32 s38, s9, 151552
    v_add_u32 v5, s38, v1
    ds_read_b128 v[40:43], v5
    s_lshl_b32 s9, s36, 6
    s_add_u32 s9, s9, 11520
    v_lshlrev_b32 v6, 4, v4
    buffer_load_dwordx4 v[44:47], v6, s[12:15], s9 offen sc1
    v_mul_u32_u24 v7, 1152, v3
    v_lshl_add_u32 v7, v4, 3, v7
    s_mul_i32 s37, s20, 36864
    s_lshl_b32 s9, s36, 5
    s_add_u32 s37, s37, s9
    s_add_u32 s38, s37, 18432
    s_waitcnt vmcnt(8)
    v_lshlrev_b32 v48, 16, v8
    v_and_b32 v49, 0xffff0000, v8
    v_lshlrev_b32 v50, 16, v9
    v_and_b32 v51, 0xffff0000, v9
    v_lshlrev_b32 v52, 16, v10
    v_and_b32 v53, 0xffff0000, v10
    v_lshlrev_b32 v54, 16, v11
    v_and_b32 v55, 0xffff0000, v11
    s_waitcnt vmcnt(7)
    v_lshlrev_b32 v56, 16, v12
    v_and_b32 v57, 0xffff0000, v12
    v_add_f32 v48, v48, v56
    v_add_f32 v49, v49, v57
    v_lshlrev_b32 v56, 16, v13
    v_and_b32 v57, 0xffff0000, v13
    v_add_f32 v50, v50, v56
    v_add_f32 v51, v51, v57
    v_lshlrev_b32 v56, 16, v14
    v_and_b32 v57, 0xffff0000, v14
    v_add_f32 v52, v52, v56
    v_add_f32 v53, v53, v57
    v_lshlrev_b32 v56, 16, v15
    v_and_b32 v57, 0xffff0000, v15
    v_add_f32 v54, v54, v56
    v_add_f32 v55, v55, v57
    s_waitcnt vmcnt(6)
    v_lshlrev_b32 v56, 16, v16
    v_and_b32 v57, 0xffff0000, v16
    v_add_f32 v48, v48, v56
    v_add_f32 v49, v49, v57
    v_lshlrev_b32 v56, 16, v17
    v_and_b32 v57, 0xffff0000, v17
    v_add_f32 v50, v50, v56
    v_add_f32 v51, v51, v57
    v_lshlrev_b32 v56, 16, v18
    v_and_b32 v57, 0xffff0000, v18
    v_add_f32 v52, v52, v56
    v_add_f32 v53, v53, v57
    v_lshlrev_b32 v56, 16, v19
    v_and_b32 v57, 0xffff0000, v19
    v_add_f32 v54, v54, v56
    v_add_f32 v55, v55, v57
    s_waitcnt vmcnt(5)
    v_lshlrev_b32 v56, 16, v20
    v_and_b32 v57, 0xffff0000, v20
    v_add_f32 v48, v48, v56
    v_add_f32 v49, v49, v57
    v_lshlrev_b32 v56, 16, v21
    v_and_b32 v57, 0xffff0000, v21
    v_add_f32 v50, v50, v56
    v_add_f32 v51, v51, v57
    v_lshlrev_b32 v56, 16, v22
    v_and_b32 v57, 0xffff0000, v22
    v_add_f32 v52, v52, v56
    v_add_f32 v53, v53, v57
    v_lshlrev_b32 v56, 16, v23
    v_and_b32 v57, 0xffff0000, v23
    v_add_f32 v54, v54, v56
    v_add_f32 v55, v55, v57
    s_waitcnt vmcnt(4)
    v_lshlrev_b32 v56, 16, v24
    v_and_b32 v57, 0xffff0000, v24
    v_add_f32 v48, v48, v56
    v_add_f32 v49, v49, v57
    v_lshlrev_b32 v56, 16, v25
    v_and_b32 v57, 0xffff0000, v25
    v_add_f32 v50, v50, v56
    v_add_f32 v51, v51, v57
    v_lshlrev_b32 v56, 16, v26
    v_and_b32 v57, 0xffff0000, v26
    v_add_f32 v52, v52, v56
    v_add_f32 v53, v53, v57
    v_lshlrev_b32 v56, 16, v27
    v_and_b32 v57, 0xffff0000, v27
    v_add_f32 v54, v54, v56
    v_add_f32 v55, v55, v57
    s_waitcnt vmcnt(3)
    v_lshlrev_b32 v56, 16, v28
    v_and_b32 v57, 0xffff0000, v28
    v_add_f32 v48, v48, v56
    v_add_f32 v49, v49, v57
    v_lshlrev_b32 v56, 16, v29
    v_and_b32 v57, 0xffff0000, v29
    v_add_f32 v50, v50, v56
    v_add_f32 v51, v51, v57
    v_lshlrev_b32 v56, 16, v30
    v_and_b32 v57, 0xffff0000, v30
    v_add_f32 v52, v52, v56
    v_add_f32 v53, v53, v57
    v_lshlrev_b32 v56, 16, v31
    v_and_b32 v57, 0xffff0000, v31
    v_add_f32 v54, v54, v56
    v_add_f32 v55, v55, v57
    s_waitcnt vmcnt(2)
    v_lshlrev_b32 v56, 16, v32
    v_and_b32 v57, 0xffff0000, v32
    v_add_f32 v48, v48, v56
    v_add_f32 v49, v49, v57
    v_lshlrev_b32 v56, 16, v33
    v_and_b32 v57, 0xffff0000, v33
    v_add_f32 v50, v50, v56
    v_add_f32 v51, v51, v57
    v_lshlrev_b32 v56, 16, v34
    v_and_b32 v57, 0xffff0000, v34
    v_add_f32 v52, v52, v56
    v_add_f32 v53, v53, v57
    v_lshlrev_b32 v56, 16, v35
    v_and_b32 v57, 0xffff0000, v35
    v_add_f32 v54, v54, v56
    v_add_f32 v55, v55, v57
    s_waitcnt vmcnt(1)
    v_lshlrev_b32 v56, 16, v36
    v_and_b32 v57, 0xffff0000, v36
    v_add_f32 v48, v48, v56
    v_add_f32 v49, v49, v57
    v_lshlrev_b32 v56, 16, v37
    v_and_b32 v57, 0xffff0000, v37
    v_add_f32 v50, v50, v56
    v_add_f32 v51, v51, v57
    v_lshlrev_b32 v56, 16, v38
    v_and_b32 v57, 0xffff0000, v38
    v_add_f32 v52, v52, v56
    v_add_f32 v53, v53, v57
    v_lshlrev_b32 v56, 16, v39
    v_and_b32 v57, 0xffff0000, v39
    v_add_f32 v54, v54, v56
    v_add_f32 v55, v55, v57
    s_waitcnt vmcnt(0) lgkmcnt(0)
    v_cvt_pk_bf16_f32 v8, v48, v49
    v_cvt_pk_bf16_f32 v9, v50, v51
    v_cvt_pk_bf16_f32 v10, v52, v53
    v_cvt_pk_bf16_f32 v11, v54, v55
    v_lshlrev_b32 v48, 16, v8
    v_and_b32 v49, 0xffff0000, v8
    v_lshlrev_b32 v50, 16, v9
    v_and_b32 v51, 0xffff0000, v9
    v_lshlrev_b32 v52, 16, v10
    v_and_b32 v53, 0xffff0000, v10
    v_lshlrev_b32 v54, 16, v11
    v_and_b32 v55, 0xffff0000, v11
    v_mul_f32 v48, v48, v44
    v_mul_f32 v49, v49, v45
    v_mul_f32 v50, v50, v46
    v_mul_f32 v51, v51, v47
    v_mul_f32 v52, v52, v44
    v_mul_f32 v53, v53, v45
    v_mul_f32 v54, v54, v46
    v_mul_f32 v55, v55, v47
    v_cvt_pk_bf16_f32 v8, v48, v49
    v_cvt_pk_bf16_f32 v9, v50, v51
    v_cvt_pk_bf16_f32 v10, v52, v53
    v_cvt_pk_bf16_f32 v11, v54, v55
    v_lshlrev_b32 v48, 16, v8
    v_and_b32 v49, 0xffff0000, v8
    v_lshlrev_b32 v16, 16, v40
    v_and_b32 v17, 0xffff0000, v40
    v_lshlrev_b32 v50, 16, v9
    v_and_b32 v51, 0xffff0000, v9
    v_lshlrev_b32 v18, 16, v41
    v_and_b32 v19, 0xffff0000, v41
    v_lshlrev_b32 v52, 16, v10
    v_and_b32 v53, 0xffff0000, v10
    v_lshlrev_b32 v20, 16, v42
    v_and_b32 v21, 0xffff0000, v42
    v_lshlrev_b32 v54, 16, v11
    v_and_b32 v55, 0xffff0000, v11
    v_lshlrev_b32 v22, 16, v43
    v_and_b32 v23, 0xffff0000, v43
    v_add_f32 v48, v48, v16
    v_add_f32 v49, v49, v17
    v_add_f32 v50, v50, v18
    v_add_f32 v51, v51, v19
    v_add_f32 v52, v52, v20
    v_add_f32 v53, v53, v21
    v_add_f32 v54, v54, v22
    v_add_f32 v55, v55, v23
    v_cvt_pk_bf16_f32 v60, v48, v49
    v_cvt_pk_bf16_f32 v61, v50, v51
    v_cvt_pk_bf16_f32 v62, v52, v53
    v_cvt_pk_bf16_f32 v63, v54, v55
    buffer_store_dwordx2 v[60:61], v7, s[16:19], s37 offen
    buffer_store_dwordx2 v[62:63], v7, s[16:19], s38 offen
    s_mov_b32 s52, s53
    s_mov_b32 s53, 9
    s_mov_b32 s54, 294912
    s_cmp_lt_u32 s52, 9
    s_cbranch_scc1 L_kb_red
L_kb_end:
    s_endpgm
L_kb_pubw:
    s_lshl_b32 s56, s22, 7
    s_lshl_b32 s11, s23, 2
    s_add_u32 s56, s56, s11
    v_mov_b32 v10, 0
    s_add_u32 s9, s56, 286720
    s_add_u32 s10, s56, 294912
    s_mov_b64 exec, 1
    buffer_load_dword v11, v10, s[12:15], s9 offen sc1
    buffer_load_dword v12, v10, s[12:15], s10 offen sc1
    s_mov_b64 exec, -1
    v_mov_b32 v8, 163328
    s_mov_b32 s11, 262144
L_kb_pw0:
    ds_read_b32 v9, v8
    s_waitcnt lgkmcnt(0)
    v_readfirstlane_b32 s9, v9
    s_cmp_ge_u32 s9, 12
    s_cbranch_scc1 L_kb_pk0
    s_sleep 2
    s_sub_u32 s11, s11, 1
    s_cmp_lg_u32 s11, 0
    s_cbranch_scc1 L_kb_pw0
L_kb_pk0:
    s_add_u32 s10, s56, 286720
    v_mov_b32 v120, s3
    v_mov_b32 v121, 0
    s_mov_b64 exec, 1
    buffer_store_dword v120, v121, s[12:15], s10 offen sc1
    s_mov_b64 exec, -1
    v_mov_b32 v8, 163332
    s_mov_b32 s11, 262144
L_kb_pw1:
    ds_read_b32 v9, v8
    s_waitcnt lgkmcnt(0)
    v_readfirstlane_b32 s9, v9
    s_cmp_ge_u32 s9, 12
    s_cbranch_scc1 L_kb_pk1
    s_sleep 2
    s_sub_u32 s11, s11, 1
    s_cmp_lg_u32 s11, 0
    s_cbranch_scc1 L_kb_pw1
L_kb_pk1:
    s_add_u32 s10, s56, 294912
    v_mov_b32 v120, s3
    v_mov_b32 v121, 0
    s_mov_b64 exec, 1
    buffer_store_dword v120, v121, s[12:15], s10 offen sc1
    s_mov_b64 exec, -1
    s_endpgm
L_kb_fallback:
    v_mov_b32 v13, 0
    v_mov_b32 v19, 0
    v_mov_b32 v80, 0xff7fffff
    v_mov_b32 v81, 0xff7fffff
    v_lshlrev_b32 v82, 2, v3
    v_mov_b32 v93, 0
    s_mov_b32 s9, 23068672
L_kb_fb_loop:
    buffer_load_dwordx4 v[88:91], v1, s[12:15], s9 offen sc1
    buffer_load_dword v92, v82, s[12:15], s9 offen offset:1024 sc1
    s_waitcnt vmcnt(0)
    v_mfma_f32_32x32x8_bf16 v[48:63], v[92:93], v[12:13], 0
    v_mfma_f32_32x32x16_bf16 v[48:63], v[88:91], v[8:11], v[48:63]
    v_mfma_f32_32x32x8_bf16 v[64:79], v[92:93], v[18:19], 0
    v_mfma_f32_32x32x16_bf16 v[64:79], v[88:91], v[14:17], v[64:79]
    s_nop 15
    v_max3_f32 v80, v80, v48, v49
    v_max3_f32 v80, v80, v50, v51
    v_max3_f32 v80, v80, v52, v53
    v_max3_f32 v80, v80, v54, v55
    v_max3_f32 v80, v80, v56, v57
    v_max3_f32 v80, v80, v58, v59
    v_max3_f32 v80, v80, v60, v61
    v_max3_f32 v80, v80, v62, v63
    v_max3_f32 v81, v81, v64, v65
    v_max3_f32 v81, v81, v66, v67
    v_max3_f32 v81, v81, v68, v69
    v_max3_f32 v81, v81, v70, v71
    v_max3_f32 v81, v81, v72, v73
    v_max3_f32 v81, v81, v74, v75
    v_max3_f32 v81, v81, v76, v77
    v_max3_f32 v81, v81, v78, v79
    s_add_u32 s9, s9, 2368
    s_cmp_lt_u32 s9, 23220224
    s_cbranch_scc1 L_kb_fb_loop
    v_mov_b32 v82, v80
    v_mov_b32 v83, v81
    s_nop 1
    v_permlane32_swap_b32 v80, v82
    v_permlane32_swap_b32 v81, v83
    s_nop 1
    v_max_f32 v80, v80, v82
    v_max_f32 v81, v81, v83
    s_branch L_kb_shift
L_kb_codeend:
    s_endpgm
.section .rodata,"a"
.p2align 6
.amdhsa_kernel adaLN_cond__grouped_kv_mqa__dense_activation_relu__prompt_kernel
  .amdhsa_next_free_vgpr 128
  .amdhsa_next_free_sgpr 100
  .amdhsa_accum_offset 128
  .amdhsa_group_segment_fixed_size 0
  .amdhsa_kernarg_size 104
  .amdhsa_user_sgpr_count 2
  .amdhsa_user_sgpr_kernarg_segment_ptr 1
  .amdhsa_system_sgpr_workgroup_id_x 1
.end_amdhsa_kernel
```
